```python
import torch

def _softmax(x, axis=-1):
    return torch.softmax(x, dim=axis)
def _gelu(x):
    return torch.nn.functional.gelu(x, approximate="tanh")
def _silu(x):
    return torch.nn.functional.silu(x)
def _sigmoid(x):
    return torch.sigmoid(x)
def _layernorm(x, axis=-1, eps=1e-5):
    m = x.mean(dim=axis, keepdim=True)
    v = x.var(dim=axis, keepdim=True, unbiased=False)
    return (x - m) / torch.sqrt(v + eps)
def _scatter_add(tgt, idx, src, axis=0):
    return tgt.clone().index_add_(axis, idx, src)
def _segment_sum(src, seg, n):
    out = torch.zeros((n,) + src.shape[1:], dtype=src.dtype)
    return out.index_add_(0, seg, src)
def _pad(x, pw):
    flat = tuple(v for pair in reversed(pw) for v in pair)
    return torch.nn.functional.pad(x, flat)

kernel_name = 'standalone__mha_block_cached__decode'

def setup_inputs():

    _w = (lambda a: (lambda t: t.to(torch.bfloat16) if t.is_floating_point() else t)(torch.as_tensor(a)))
    B, Sq, D = 4, 1, 448
    H, Sk, Dh = 16, 8192, 256
    return {
        "x": _w((lambda *s: torch.randn(*s, dtype=torch.bfloat16) * 0.8)(B, Sq, D)),
        "k_cache": _w((lambda *s: torch.randn(*s, dtype=torch.bfloat16) * 0.8)(B, H, Sk, Dh)),
        "v_cache": _w((lambda *s: torch.randn(*s, dtype=torch.bfloat16) * 0.05)(B, H, Sk, Dh)),
        "wq": _w((lambda *s: torch.randn(*s, dtype=torch.bfloat16) * 0.8)(D, H * Dh) * (D ** -0.5)),
        "wo": _w((lambda *s: torch.randn(*s, dtype=torch.bfloat16) * 0.05)(H * Dh, D) * ((H * Dh) ** -0.5)),
    }

def reference(x, k_cache, v_cache, wq, wo):
    B, Sq, D = x.shape
    H, Dh = 16, 256
    q = (lambda x, *d: x.permute(*d))((x @ wq).reshape(B, Sq, H, Dh), 0, 2, 1, 3)
    scores = torch.einsum("bhqd,bhkd->bhqk", q, k_cache) * (Dh ** -0.5)
    p = _softmax(scores, axis=-1)
    o = torch.einsum("bhqk,bhkd->bhqd", p, v_cache)
    return (lambda x, *d: x.permute(*d))(o, 0, 2, 1, 3).reshape(B, Sq, H * Dh) @ wo
```

```asm
; @launch grid=(256,1,1) block=(512,1,1) lds=12288
.amdgcn_target "amdgcn-amd-amdhsa--gfx950"
.text
.globl standalone__mha_block_cached__decode_kernel
.p2align 8
.type standalone__mha_block_cached__decode_kernel,@function
standalone__mha_block_cached__decode_kernel:
  s_cmp_ge_u32 s2, 0x100
  s_cbranch_scc1 L_end
  s_load_dwordx2 s[8:9], s[0:1], 8
  s_load_dwordx2 s[12:13], s[0:1], 16
  s_load_dwordx2 s[16:17], s[0:1], 56
  s_load_dwordx2 s[20:21], s[0:1], 0
  s_load_dwordx2 s[24:25], s[0:1], 24
  s_load_dwordx2 s[28:29], s[0:1], 32
  s_load_dwordx2 s[32:33], s[0:1], 40
  v_lshrrev_b32 v2, 6, v0
  v_and_b32 v1, 63, v0
  v_readfirstlane_b32 s3, v2
  s_lshr_b32 s36, s2, 2
  s_and_b32 s37, s2, 3
  s_lshr_b32 s38, s36, 4
  s_and_b32 s39, s36, 15
  s_and_b32 s40, s3, 3
  s_cmp_ge_u32 s3, 4
  s_cbranch_scc1 L_helper
  s_lshl_b32 s42, s37, 2
  s_add_u32 s42, s42, s40
  s_lshl_b32 s52, s36, 22
  v_lshl_add_u32 v2, v1, 4, s52
  v_add_u32 v3, 0x1000, v2
  s_lshl_b32 s44, s42, 13
  s_add_u32 s45, s44, 0x20000
  s_mov_b32 s10, 0x10000000
  s_mov_b32 s11, 0x20000
  s_mov_b32 s14, 0x10000000
  s_mov_b32 s15, 0x20000
  s_mov_b32 s18, 0x400000
  s_mov_b32 s19, 0x20000
  s_mov_b32 s48, 0x3db8aa3b
  s_mov_b32 s49, 0x07060500
  s_mov_b32 s50, 0xff
  s_mov_b32 s51, 0x400000
  s_waitcnt lgkmcnt(0)
  s_and_b32 s9, s9, 0xffff
  s_and_b32 s13, s13, 0xffff
  s_and_b32 s17, s17, 0xffff
  buffer_load_dwordx4 v[64:67], v2, s[8:11], s44 offen offset:0 nt
  buffer_load_dwordx4 v[68:71], v2, s[8:11], s44 offen offset:1024 nt
  buffer_load_dwordx4 v[72:75], v2, s[8:11], s44 offen offset:2048 nt
  buffer_load_dwordx4 v[76:79], v2, s[8:11], s44 offen offset:3072 nt
  buffer_load_dwordx4 v[80:83], v3, s[8:11], s44 offen offset:0 nt
  buffer_load_dwordx4 v[84:87], v3, s[8:11], s44 offen offset:1024 nt
  v_and_b32 v21, 1, v1
  v_lshlrev_b32 v21, 4, v21
  v_mov_b32 v27, 0xffff
  v_lshlrev_b32 v21, v21, v27
  v_lshrrev_b32 v27, 1, v1
  v_xor_b32 v27, v27, v1
  v_bfe_u32 v27, v27, 3, 1
  v_bfe_u32 v8, v1, 1, 2
  v_lshl_or_b32 v27, v27, 2, v8
  v_cmp_eq_u32 s[56:57], 0, v27
  v_cmp_eq_u32 s[58:59], 1, v27
  v_cmp_eq_u32 s[60:61], 2, v27
  v_cmp_eq_u32 vcc, 3, v27
  v_cndmask_b32 v8, 0, v21, s[56:57]
  v_cndmask_b32 v9, 0, v21, s[58:59]
  v_cndmask_b32 v10, 0, v21, s[60:61]
  v_cndmask_b32 v11, 0, v21, vcc
  s_mov_b32 s54, 0xcccccccc
  s_mov_b32 s55, 0xcccccccc
  v_mov_b32 v22, 0xff61b1e6
  v_mov_b32 v23, 0
  v_mov_b32 v24, 0
  v_mov_b32 v28, 0
  v_mov_b32 v29, 0
  v_mov_b32 v30, 0
  v_mov_b32 v31, 0
  v_and_b32 v27, 31, v1
  v_lshlrev_b32 v27, 4, v27
  v_mov_b32 v21, 512
  s_lshl_b32 s43, s40, 2
  s_add_u32 s43, s43, 544
  v_mov_b32 v192, s43
  s_lshl_b32 s43, s40, 10
  s_add_u32 s43, s43, 916
  v_mov_b32 v193, s43
  s_lshl_b32 s43, s36, 4
  s_add_u32 s43, s43, s42
  s_lshl_b32 s52, s43, 4
  s_add_u32 s52, s52, 0x210000
  v_mov_b32 v196, s52
  s_lshl_b32 s43, s43, 10
  s_add_u32 s43, s43, 0x110000
  v_lshl_add_u32 v195, v1, 4, s43
  s_waitcnt vmcnt(5)
  buffer_load_dwordx4 v[88:91], v3, s[8:11], s44 offen offset:2048 nt
  s_waitcnt vmcnt(5)
  buffer_load_dwordx4 v[92:95], v3, s[8:11], s44 offen offset:3072 nt
  s_waitcnt vmcnt(5)
  buffer_load_dwordx4 v[128:131], v2, s[12:15], s44 offen offset:0 nt
  s_waitcnt vmcnt(5)
  buffer_load_dwordx4 v[132:135], v2, s[12:15], s44 offen offset:1024 nt
  s_waitcnt vmcnt(5)
  buffer_load_dwordx4 v[136:139], v2, s[12:15], s44 offen offset:2048 nt
  s_waitcnt vmcnt(5)
  buffer_load_dwordx4 v[140:143], v2, s[12:15], s44 offen offset:3072 nt
  s_waitcnt vmcnt(5)
  buffer_load_dwordx4 v[144:147], v3, s[12:15], s44 offen offset:0 nt
  s_waitcnt vmcnt(5)
  buffer_load_dwordx4 v[148:151], v3, s[12:15], s44 offen offset:1024 nt
  s_waitcnt vmcnt(5)
  buffer_load_dwordx4 v[152:155], v3, s[12:15], s44 offen offset:2048 nt
  s_waitcnt vmcnt(5)
  buffer_load_dwordx4 v[156:159], v3, s[12:15], s44 offen offset:3072 nt
  s_waitcnt vmcnt(5)
  buffer_load_dwordx4 v[96:99], v2, s[8:11], s45 offen offset:0 nt
  s_waitcnt vmcnt(5)
  buffer_load_dwordx4 v[100:103], v2, s[8:11], s45 offen offset:1024 nt
  s_waitcnt vmcnt(5)
  buffer_load_dwordx4 v[104:107], v2, s[8:11], s45 offen offset:2048 nt
  s_waitcnt vmcnt(5)
  buffer_load_dwordx4 v[108:111], v2, s[8:11], s45 offen offset:3072 nt
  s_waitcnt vmcnt(5)
  buffer_load_dwordx4 v[112:115], v3, s[8:11], s45 offen offset:0 nt
  s_waitcnt vmcnt(5)
  buffer_load_dwordx4 v[116:119], v3, s[8:11], s45 offen offset:1024 nt
  s_waitcnt vmcnt(5)
  buffer_load_dwordx4 v[120:123], v3, s[8:11], s45 offen offset:2048 nt
  s_waitcnt vmcnt(5)
  buffer_load_dwordx4 v[124:127], v3, s[8:11], s45 offen offset:3072 nt
  s_waitcnt vmcnt(5)
  buffer_load_dwordx4 v[160:163], v2, s[12:15], s45 offen offset:0 nt
  s_waitcnt vmcnt(5)
  buffer_load_dwordx4 v[164:167], v2, s[12:15], s45 offen offset:1024 nt
  s_waitcnt vmcnt(5)
  buffer_load_dwordx4 v[168:171], v2, s[12:15], s45 offen offset:2048 nt
  s_waitcnt vmcnt(5)
  buffer_load_dwordx4 v[172:175], v2, s[12:15], s45 offen offset:3072 nt
  s_waitcnt vmcnt(5)
  buffer_load_dwordx4 v[176:179], v3, s[12:15], s45 offen offset:0 nt
  s_waitcnt vmcnt(5)
  buffer_load_dwordx4 v[180:183], v3, s[12:15], s45 offen offset:1024 nt
  s_waitcnt vmcnt(5)
  buffer_load_dwordx4 v[184:187], v3, s[12:15], s45 offen offset:2048 nt
  s_waitcnt vmcnt(5)
  buffer_load_dwordx4 v[188:191], v3, s[12:15], s45 offen offset:3072 nt
  s_mov_b32 s46, 2
  s_barrier
  ds_read_b128 v[4:7], v27 offset:0
  ds_read_b32 v26, v21
  s_waitcnt lgkmcnt(0)
L_loop:
  s_cmp_lt_u32 s46, 27
  s_cbranch_scc1 L_static0
  s_lshl_b32 s42, s46, 2
  v_add_u32 v27, s42, v193
L_spin0:
  ds_read_b32 v194, v27
  s_waitcnt lgkmcnt(0)
  v_readfirstlane_b32 s47, v194
  s_cmp_lg_u32 s47, 0xffffffff
  s_cbranch_scc1 L_have0
  s_sub_u32 s51, s51, 1
  s_cbranch_scc0 L_spin0
  s_branch L_tail0
L_have0:
  s_cmp_ge_u32 s47, 0x80000000
  s_cbranch_scc1 L_tail0
  s_and_b32 s44, s47, 0xfffffffe
  s_add_u32 s46, s46, 1
  s_and_b32 s42, s47, 1
  s_branch L_body0
L_static0:
  s_add_u32 s44, s44, 0x40000
L_go0:
  s_add_u32 s46, s46, 1
L_body0:
  s_waitcnt vmcnt(16)
  v_dot2_f32_bf16 v12, v64, v4, 0
  v_dot2_f32_bf16 v12, v65, v5, v12
  v_dot2_f32_bf16 v12, v66, v6, v12
  v_dot2_f32_bf16 v12, v67, v7, v12
  s_cbranch_scc1 L_np0
  s_waitcnt vmcnt(5)
L_np0:
  buffer_load_dwordx4 v[64:67], v2, s[8:11], s44 offen offset:0 nt
  v_dot2_f32_bf16 v13, v68, v4, 0
  v_dot2_f32_bf16 v13, v69, v5, v13
  v_dot2_f32_bf16 v13, v70, v6, v13
  v_dot2_f32_bf16 v13, v71, v7, v13
  s_cbranch_scc1 L_np1
  s_waitcnt vmcnt(5)
L_np1:
  buffer_load_dwordx4 v[68:71], v2, s[8:11], s44 offen offset:1024 nt
  v_dot2_f32_bf16 v14, v72, v4, 0
  v_dot2_f32_bf16 v14, v73, v5, v14
  v_dot2_f32_bf16 v14, v74, v6, v14
  v_dot2_f32_bf16 v14, v75, v7, v14
  s_cbranch_scc1 L_np2
  s_waitcnt vmcnt(5)
L_np2:
  buffer_load_dwordx4 v[72:75], v2, s[8:11], s44 offen offset:2048 nt
  v_dot2_f32_bf16 v15, v76, v4, 0
  v_dot2_f32_bf16 v15, v77, v5, v15
  v_dot2_f32_bf16 v15, v78, v6, v15
  v_dot2_f32_bf16 v15, v79, v7, v15
  s_cbranch_scc1 L_np3
  s_waitcnt vmcnt(5)
L_np3:
  buffer_load_dwordx4 v[76:79], v2, s[8:11], s44 offen offset:3072 nt
  v_dot2_f32_bf16 v16, v80, v4, 0
  v_dot2_f32_bf16 v16, v81, v5, v16
  v_dot2_f32_bf16 v16, v82, v6, v16
  v_dot2_f32_bf16 v16, v83, v7, v16
  s_cbranch_scc1 L_np4
  s_waitcnt vmcnt(5)
L_np4:
  buffer_load_dwordx4 v[80:83], v3, s[8:11], s44 offen offset:0 nt
  v_dot2_f32_bf16 v17, v84, v4, 0
  v_dot2_f32_bf16 v17, v85, v5, v17
  v_dot2_f32_bf16 v17, v86, v6, v17
  v_dot2_f32_bf16 v17, v87, v7, v17
  s_cbranch_scc1 L_np5
  s_waitcnt vmcnt(5)
L_np5:
  buffer_load_dwordx4 v[84:87], v3, s[8:11], s44 offen offset:1024 nt
  v_dot2_f32_bf16 v18, v88, v4, 0
  v_dot2_f32_bf16 v18, v89, v5, v18
  v_dot2_f32_bf16 v18, v90, v6, v18
  v_dot2_f32_bf16 v18, v91, v7, v18
  s_cbranch_scc1 L_np6
  s_waitcnt vmcnt(5)
L_np6:
  buffer_load_dwordx4 v[88:91], v3, s[8:11], s44 offen offset:2048 nt
  v_dot2_f32_bf16 v19, v92, v4, 0
  v_dot2_f32_bf16 v19, v93, v5, v19
  v_dot2_f32_bf16 v19, v94, v6, v19
  v_dot2_f32_bf16 v19, v95, v7, v19
  s_cbranch_scc1 L_np7
  s_waitcnt vmcnt(5)
L_np7:
  buffer_load_dwordx4 v[92:95], v3, s[8:11], s44 offen offset:3072 nt
  v_mov_b32 v194, s46
  ds_write_b32 v192, v194
  v_add_f32_dpp v12, v12, v12 row_mirror row_mask:0xf bank_mask:0x3
  v_add_f32_dpp v13, v13, v13 row_mirror row_mask:0xf bank_mask:0x3
  v_add_f32_dpp v14, v14, v14 row_mirror row_mask:0xf bank_mask:0x3
  v_add_f32_dpp v15, v15, v15 row_mirror row_mask:0xf bank_mask:0x3
  v_add_f32_dpp v12, v16, v16 row_mirror row_mask:0xf bank_mask:0xc
  v_add_f32_dpp v13, v17, v17 row_mirror row_mask:0xf bank_mask:0xc
  v_add_f32_dpp v14, v18, v18 row_mirror row_mask:0xf bank_mask:0xc
  v_add_f32_dpp v15, v19, v19 row_mirror row_mask:0xf bank_mask:0xc
  v_add_f32_dpp v12, v12, v12 row_half_mirror row_mask:0xf bank_mask:0x5
  v_add_f32_dpp v13, v13, v13 row_half_mirror row_mask:0xf bank_mask:0x5
  s_nop 0
  v_add_f32_dpp v12, v14, v14 row_half_mirror row_mask:0xf bank_mask:0xa
  v_add_f32_dpp v13, v15, v15 row_half_mirror row_mask:0xf bank_mask:0xa
  s_nop 0
  v_add_f32_dpp v20, v12, v12 quad_perm:[2,3,0,1] row_mask:0xf bank_mask:0xf
  v_add_f32_dpp v21, v13, v13 quad_perm:[2,3,0,1] row_mask:0xf bank_mask:0xf
  v_cndmask_b32 v20, v20, v21, s[54:55]
  s_nop 1
  v_add_f32_dpp v20, v20, v20 quad_perm:[1,0,3,2] row_mask:0xf bank_mask:0xf
  v_mov_b32 v21, v20
  s_nop 1
  v_permlane16_swap_b32 v20, v21
  v_add_f32 v20, v20, v21
  v_cmp_gt_f32 vcc, v20, v22
  s_cbranch_vccnz L_slow0
L_back0:
  v_fma_f32 v21, v20, s48, -v23
  v_exp_f32 v25, v21
  s_nop 0
  v_add_f32 v24, v24, v25
  v_cvt_pk_bf16_f32 v25, v25, v25
  s_nop 1
  v_and_b32_dpp v32, v25, v8 row_newbcast:0 row_mask:0xf bank_mask:0xf
  v_and_b32_dpp v33, v25, v9 row_newbcast:0 row_mask:0xf bank_mask:0xf
  v_and_b32_dpp v34, v25, v10 row_newbcast:0 row_mask:0xf bank_mask:0xf
  v_and_b32_dpp v35, v25, v11 row_newbcast:0 row_mask:0xf bank_mask:0xf
  v_and_b32_dpp v36, v25, v8 row_newbcast:2 row_mask:0xf bank_mask:0xf
  v_and_b32_dpp v37, v25, v9 row_newbcast:2 row_mask:0xf bank_mask:0xf
  v_and_b32_dpp v38, v25, v10 row_newbcast:2 row_mask:0xf bank_mask:0xf
  v_and_b32_dpp v39, v25, v11 row_newbcast:2 row_mask:0xf bank_mask:0xf
  v_and_b32_dpp v40, v25, v8 row_newbcast:4 row_mask:0xf bank_mask:0xf
  v_and_b32_dpp v41, v25, v9 row_newbcast:4 row_mask:0xf bank_mask:0xf
  v_and_b32_dpp v42, v25, v10 row_newbcast:4 row_mask:0xf bank_mask:0xf
  v_and_b32_dpp v43, v25, v11 row_newbcast:4 row_mask:0xf bank_mask:0xf
  v_and_b32_dpp v44, v25, v8 row_newbcast:6 row_mask:0xf bank_mask:0xf
  v_and_b32_dpp v45, v25, v9 row_newbcast:6 row_mask:0xf bank_mask:0xf
  v_and_b32_dpp v46, v25, v10 row_newbcast:6 row_mask:0xf bank_mask:0xf
  v_and_b32_dpp v47, v25, v11 row_newbcast:6 row_mask:0xf bank_mask:0xf
  v_and_b32_dpp v48, v25, v8 row_newbcast:8 row_mask:0xf bank_mask:0xf
  v_and_b32_dpp v49, v25, v9 row_newbcast:8 row_mask:0xf bank_mask:0xf
  v_and_b32_dpp v50, v25, v10 row_newbcast:8 row_mask:0xf bank_mask:0xf
  v_and_b32_dpp v51, v25, v11 row_newbcast:8 row_mask:0xf bank_mask:0xf
  v_and_b32_dpp v52, v25, v8 row_newbcast:10 row_mask:0xf bank_mask:0xf
  v_and_b32_dpp v53, v25, v9 row_newbcast:10 row_mask:0xf bank_mask:0xf
  v_and_b32_dpp v54, v25, v10 row_newbcast:10 row_mask:0xf bank_mask:0xf
  v_and_b32_dpp v55, v25, v11 row_newbcast:10 row_mask:0xf bank_mask:0xf
  v_and_b32_dpp v56, v25, v8 row_newbcast:12 row_mask:0xf bank_mask:0xf
  v_and_b32_dpp v57, v25, v9 row_newbcast:12 row_mask:0xf bank_mask:0xf
  v_and_b32_dpp v58, v25, v10 row_newbcast:12 row_mask:0xf bank_mask:0xf
  v_and_b32_dpp v59, v25, v11 row_newbcast:12 row_mask:0xf bank_mask:0xf
  v_and_b32_dpp v60, v25, v8 row_newbcast:14 row_mask:0xf bank_mask:0xf
  v_and_b32_dpp v61, v25, v9 row_newbcast:14 row_mask:0xf bank_mask:0xf
  v_and_b32_dpp v62, v25, v10 row_newbcast:14 row_mask:0xf bank_mask:0xf
  v_and_b32_dpp v63, v25, v11 row_newbcast:14 row_mask:0xf bank_mask:0xf
  v_mfma_f32_16x16x32_bf16 v[28:31], v[128:131], v[32:35], v[28:31]
  s_cbranch_scc1 L_np8
  s_waitcnt vmcnt(5)
L_np8:
  buffer_load_dwordx4 v[128:131], v2, s[12:15], s44 offen offset:0 nt
  v_mfma_f32_16x16x32_bf16 v[28:31], v[132:135], v[36:39], v[28:31]
  s_cbranch_scc1 L_np9
  s_waitcnt vmcnt(5)
L_np9:
  buffer_load_dwordx4 v[132:135], v2, s[12:15], s44 offen offset:1024 nt
  v_mfma_f32_16x16x32_bf16 v[28:31], v[136:139], v[40:43], v[28:31]
  s_cbranch_scc1 L_np10
  s_waitcnt vmcnt(5)
L_np10:
  buffer_load_dwordx4 v[136:139], v2, s[12:15], s44 offen offset:2048 nt
  v_mfma_f32_16x16x32_bf16 v[28:31], v[140:143], v[44:47], v[28:31]
  s_cbranch_scc1 L_np11
  s_waitcnt vmcnt(5)
L_np11:
  buffer_load_dwordx4 v[140:143], v2, s[12:15], s44 offen offset:3072 nt
  v_mfma_f32_16x16x32_bf16 v[28:31], v[144:147], v[48:51], v[28:31]
  s_cbranch_scc1 L_np12
  s_waitcnt vmcnt(5)
L_np12:
  buffer_load_dwordx4 v[144:147], v3, s[12:15], s44 offen offset:0 nt
  v_mfma_f32_16x16x32_bf16 v[28:31], v[148:151], v[52:55], v[28:31]
  s_cbranch_scc1 L_np13
  s_waitcnt vmcnt(5)
L_np13:
  buffer_load_dwordx4 v[148:151], v3, s[12:15], s44 offen offset:1024 nt
  v_mfma_f32_16x16x32_bf16 v[28:31], v[152:155], v[56:59], v[28:31]
  s_cbranch_scc1 L_np14
  s_waitcnt vmcnt(5)
L_np14:
  buffer_load_dwordx4 v[152:155], v3, s[12:15], s44 offen offset:2048 nt
  v_mfma_f32_16x16x32_bf16 v[28:31], v[156:159], v[60:63], v[28:31]
  s_cbranch_scc1 L_np15
  s_waitcnt vmcnt(5)
L_np15:
  buffer_load_dwordx4 v[156:159], v3, s[12:15], s44 offen offset:3072 nt
  s_cmp_lt_u32 s46, 27
  s_cbranch_scc1 L_static1
  s_lshl_b32 s42, s46, 2
  v_add_u32 v27, s42, v193
L_spin1:
  ds_read_b32 v194, v27
  s_waitcnt lgkmcnt(0)
  v_readfirstlane_b32 s47, v194
  s_cmp_lg_u32 s47, 0xffffffff
  s_cbranch_scc1 L_have1
  s_sub_u32 s51, s51, 1
  s_cbranch_scc0 L_spin1
  s_branch L_tail1
L_have1:
  s_cmp_ge_u32 s47, 0x80000000
  s_cbranch_scc1 L_tail1
  s_and_b32 s45, s47, 0xfffffffe
  s_add_u32 s46, s46, 1
  s_and_b32 s42, s47, 1
  s_branch L_body1
L_static1:
  s_add_u32 s45, s45, 0x40000
L_go1:
  s_add_u32 s46, s46, 1
L_body1:
  s_waitcnt vmcnt(16)
  v_dot2_f32_bf16 v12, v96, v4, 0
  v_dot2_f32_bf16 v12, v97, v5, v12
  v_dot2_f32_bf16 v12, v98, v6, v12
  v_dot2_f32_bf16 v12, v99, v7, v12
  s_cbranch_scc1 L_np16
  s_waitcnt vmcnt(5)
L_np16:
  buffer_load_dwordx4 v[96:99], v2, s[8:11], s45 offen offset:0 nt
  v_dot2_f32_bf16 v13, v100, v4, 0
  v_dot2_f32_bf16 v13, v101, v5, v13
  v_dot2_f32_bf16 v13, v102, v6, v13
  v_dot2_f32_bf16 v13, v103, v7, v13
  s_cbranch_scc1 L_np17
  s_waitcnt vmcnt(5)
L_np17:
  buffer_load_dwordx4 v[100:103], v2, s[8:11], s45 offen offset:1024 nt
  v_dot2_f32_bf16 v14, v104, v4, 0
  v_dot2_f32_bf16 v14, v105, v5, v14
  v_dot2_f32_bf16 v14, v106, v6, v14
  v_dot2_f32_bf16 v14, v107, v7, v14
  s_cbranch_scc1 L_np18
  s_waitcnt vmcnt(5)
L_np18:
  buffer_load_dwordx4 v[104:107], v2, s[8:11], s45 offen offset:2048 nt
  v_dot2_f32_bf16 v15, v108, v4, 0
  v_dot2_f32_bf16 v15, v109, v5, v15
  v_dot2_f32_bf16 v15, v110, v6, v15
  v_dot2_f32_bf16 v15, v111, v7, v15
  s_cbranch_scc1 L_np19
  s_waitcnt vmcnt(5)
L_np19:
  buffer_load_dwordx4 v[108:111], v2, s[8:11], s45 offen offset:3072 nt
  v_dot2_f32_bf16 v16, v112, v4, 0
  v_dot2_f32_bf16 v16, v113, v5, v16
  v_dot2_f32_bf16 v16, v114, v6, v16
  v_dot2_f32_bf16 v16, v115, v7, v16
  s_cbranch_scc1 L_np20
  s_waitcnt vmcnt(5)
L_np20:
  buffer_load_dwordx4 v[112:115], v3, s[8:11], s45 offen offset:0 nt
  v_dot2_f32_bf16 v17, v116, v4, 0
  v_dot2_f32_bf16 v17, v117, v5, v17
  v_dot2_f32_bf16 v17, v118, v6, v17
  v_dot2_f32_bf16 v17, v119, v7, v17
  s_cbranch_scc1 L_np21
  s_waitcnt vmcnt(5)
L_np21:
  buffer_load_dwordx4 v[116:119], v3, s[8:11], s45 offen offset:1024 nt
  v_dot2_f32_bf16 v18, v120, v4, 0
  v_dot2_f32_bf16 v18, v121, v5, v18
  v_dot2_f32_bf16 v18, v122, v6, v18
  v_dot2_f32_bf16 v18, v123, v7, v18
  s_cbranch_scc1 L_np22
  s_waitcnt vmcnt(5)
L_np22:
  buffer_load_dwordx4 v[120:123], v3, s[8:11], s45 offen offset:2048 nt
  v_dot2_f32_bf16 v19, v124, v4, 0
  v_dot2_f32_bf16 v19, v125, v5, v19
  v_dot2_f32_bf16 v19, v126, v6, v19
  v_dot2_f32_bf16 v19, v127, v7, v19
  s_cbranch_scc1 L_np23
  s_waitcnt vmcnt(5)
L_np23:
  buffer_load_dwordx4 v[124:127], v3, s[8:11], s45 offen offset:3072 nt
  v_mov_b32 v194, s46
  ds_write_b32 v192, v194
  v_add_f32_dpp v12, v12, v12 row_mirror row_mask:0xf bank_mask:0x3
  v_add_f32_dpp v13, v13, v13 row_mirror row_mask:0xf bank_mask:0x3
  v_add_f32_dpp v14, v14, v14 row_mirror row_mask:0xf bank_mask:0x3
  v_add_f32_dpp v15, v15, v15 row_mirror row_mask:0xf bank_mask:0x3
  v_add_f32_dpp v12, v16, v16 row_mirror row_mask:0xf bank_mask:0xc
  v_add_f32_dpp v13, v17, v17 row_mirror row_mask:0xf bank_mask:0xc
  v_add_f32_dpp v14, v18, v18 row_mirror row_mask:0xf bank_mask:0xc
  v_add_f32_dpp v15, v19, v19 row_mirror row_mask:0xf bank_mask:0xc
  v_add_f32_dpp v12, v12, v12 row_half_mirror row_mask:0xf bank_mask:0x5
  v_add_f32_dpp v13, v13, v13 row_half_mirror row_mask:0xf bank_mask:0x5
  s_nop 0
  v_add_f32_dpp v12, v14, v14 row_half_mirror row_mask:0xf bank_mask:0xa
  v_add_f32_dpp v13, v15, v15 row_half_mirror row_mask:0xf bank_mask:0xa
  s_nop 0
  v_add_f32_dpp v20, v12, v12 quad_perm:[2,3,0,1] row_mask:0xf bank_mask:0xf
  v_add_f32_dpp v21, v13, v13 quad_perm:[2,3,0,1] row_mask:0xf bank_mask:0xf
  v_cndmask_b32 v20, v20, v21, s[54:55]
  s_nop 1
  v_add_f32_dpp v20, v20, v20 quad_perm:[1,0,3,2] row_mask:0xf bank_mask:0xf
  v_mov_b32 v21, v20
  s_nop 1
  v_permlane16_swap_b32 v20, v21
  v_add_f32 v20, v20, v21
  v_cmp_gt_f32 vcc, v20, v22
  s_cbranch_vccnz L_slow1
L_back1:
  v_fma_f32 v21, v20, s48, -v23
  v_exp_f32 v25, v21
  s_nop 0
  v_add_f32 v24, v24, v25
  v_cvt_pk_bf16_f32 v25, v25, v25
  s_nop 1
  v_and_b32_dpp v32, v25, v8 row_newbcast:0 row_mask:0xf bank_mask:0xf
  v_and_b32_dpp v33, v25, v9 row_newbcast:0 row_mask:0xf bank_mask:0xf
  v_and_b32_dpp v34, v25, v10 row_newbcast:0 row_mask:0xf bank_mask:0xf
  v_and_b32_dpp v35, v25, v11 row_newbcast:0 row_mask:0xf bank_mask:0xf
  v_and_b32_dpp v36, v25, v8 row_newbcast:2 row_mask:0xf bank_mask:0xf
  v_and_b32_dpp v37, v25, v9 row_newbcast:2 row_mask:0xf bank_mask:0xf
  v_and_b32_dpp v38, v25, v10 row_newbcast:2 row_mask:0xf bank_mask:0xf
  v_and_b32_dpp v39, v25, v11 row_newbcast:2 row_mask:0xf bank_mask:0xf
  v_and_b32_dpp v40, v25, v8 row_newbcast:4 row_mask:0xf bank_mask:0xf
  v_and_b32_dpp v41, v25, v9 row_newbcast:4 row_mask:0xf bank_mask:0xf
  v_and_b32_dpp v42, v25, v10 row_newbcast:4 row_mask:0xf bank_mask:0xf
  v_and_b32_dpp v43, v25, v11 row_newbcast:4 row_mask:0xf bank_mask:0xf
  v_and_b32_dpp v44, v25, v8 row_newbcast:6 row_mask:0xf bank_mask:0xf
  v_and_b32_dpp v45, v25, v9 row_newbcast:6 row_mask:0xf bank_mask:0xf
  v_and_b32_dpp v46, v25, v10 row_newbcast:6 row_mask:0xf bank_mask:0xf
  v_and_b32_dpp v47, v25, v11 row_newbcast:6 row_mask:0xf bank_mask:0xf
  v_and_b32_dpp v48, v25, v8 row_newbcast:8 row_mask:0xf bank_mask:0xf
  v_and_b32_dpp v49, v25, v9 row_newbcast:8 row_mask:0xf bank_mask:0xf
  v_and_b32_dpp v50, v25, v10 row_newbcast:8 row_mask:0xf bank_mask:0xf
  v_and_b32_dpp v51, v25, v11 row_newbcast:8 row_mask:0xf bank_mask:0xf
  v_and_b32_dpp v52, v25, v8 row_newbcast:10 row_mask:0xf bank_mask:0xf
  v_and_b32_dpp v53, v25, v9 row_newbcast:10 row_mask:0xf bank_mask:0xf
  v_and_b32_dpp v54, v25, v10 row_newbcast:10 row_mask:0xf bank_mask:0xf
  v_and_b32_dpp v55, v25, v11 row_newbcast:10 row_mask:0xf bank_mask:0xf
  v_and_b32_dpp v56, v25, v8 row_newbcast:12 row_mask:0xf bank_mask:0xf
  v_and_b32_dpp v57, v25, v9 row_newbcast:12 row_mask:0xf bank_mask:0xf
  v_and_b32_dpp v58, v25, v10 row_newbcast:12 row_mask:0xf bank_mask:0xf
  v_and_b32_dpp v59, v25, v11 row_newbcast:12 row_mask:0xf bank_mask:0xf
  v_and_b32_dpp v60, v25, v8 row_newbcast:14 row_mask:0xf bank_mask:0xf
  v_and_b32_dpp v61, v25, v9 row_newbcast:14 row_mask:0xf bank_mask:0xf
  v_and_b32_dpp v62, v25, v10 row_newbcast:14 row_mask:0xf bank_mask:0xf
  v_and_b32_dpp v63, v25, v11 row_newbcast:14 row_mask:0xf bank_mask:0xf
  v_mfma_f32_16x16x32_bf16 v[28:31], v[160:163], v[32:35], v[28:31]
  s_cbranch_scc1 L_np24
  s_waitcnt vmcnt(5)
L_np24:
  buffer_load_dwordx4 v[160:163], v2, s[12:15], s45 offen offset:0 nt
  v_mfma_f32_16x16x32_bf16 v[28:31], v[164:167], v[36:39], v[28:31]
  s_cbranch_scc1 L_np25
  s_waitcnt vmcnt(5)
L_np25:
  buffer_load_dwordx4 v[164:167], v2, s[12:15], s45 offen offset:1024 nt
  v_mfma_f32_16x16x32_bf16 v[28:31], v[168:171], v[40:43], v[28:31]
  s_cbranch_scc1 L_np26
  s_waitcnt vmcnt(5)
L_np26:
  buffer_load_dwordx4 v[168:171], v2, s[12:15], s45 offen offset:2048 nt
  v_mfma_f32_16x16x32_bf16 v[28:31], v[172:175], v[44:47], v[28:31]
  s_cbranch_scc1 L_np27
  s_waitcnt vmcnt(5)
L_np27:
  buffer_load_dwordx4 v[172:175], v2, s[12:15], s45 offen offset:3072 nt
  v_mfma_f32_16x16x32_bf16 v[28:31], v[176:179], v[48:51], v[28:31]
  s_cbranch_scc1 L_np28
  s_waitcnt vmcnt(5)
L_np28:
  buffer_load_dwordx4 v[176:179], v3, s[12:15], s45 offen offset:0 nt
  v_mfma_f32_16x16x32_bf16 v[28:31], v[180:183], v[52:55], v[28:31]
  s_cbranch_scc1 L_np29
  s_waitcnt vmcnt(5)
L_np29:
  buffer_load_dwordx4 v[180:183], v3, s[12:15], s45 offen offset:1024 nt
  v_mfma_f32_16x16x32_bf16 v[28:31], v[184:187], v[56:59], v[28:31]
  s_cbranch_scc1 L_np30
  s_waitcnt vmcnt(5)
L_np30:
  buffer_load_dwordx4 v[184:187], v3, s[12:15], s45 offen offset:2048 nt
  v_mfma_f32_16x16x32_bf16 v[28:31], v[188:191], v[60:63], v[28:31]
  s_cbranch_scc1 L_np31
  s_waitcnt vmcnt(5)
L_np31:
  buffer_load_dwordx4 v[188:191], v3, s[12:15], s45 offen offset:3072 nt
  s_branch L_loop
L_tail0:
  s_waitcnt vmcnt(31)
  v_dot2_f32_bf16 v12, v64, v4, 0
  v_dot2_f32_bf16 v12, v65, v5, v12
  v_dot2_f32_bf16 v12, v66, v6, v12
  v_dot2_f32_bf16 v12, v67, v7, v12
  s_waitcnt vmcnt(30)
  v_dot2_f32_bf16 v13, v68, v4, 0
  v_dot2_f32_bf16 v13, v69, v5, v13
  v_dot2_f32_bf16 v13, v70, v6, v13
  v_dot2_f32_bf16 v13, v71, v7, v13
  s_waitcnt vmcnt(29)
  v_dot2_f32_bf16 v14, v72, v4, 0
  v_dot2_f32_bf16 v14, v73, v5, v14
  v_dot2_f32_bf16 v14, v74, v6, v14
  v_dot2_f32_bf16 v14, v75, v7, v14
  s_waitcnt vmcnt(28)
  v_dot2_f32_bf16 v15, v76, v4, 0
  v_dot2_f32_bf16 v15, v77, v5, v15
  v_dot2_f32_bf16 v15, v78, v6, v15
  v_dot2_f32_bf16 v15, v79, v7, v15
  s_waitcnt vmcnt(27)
  v_dot2_f32_bf16 v16, v80, v4, 0
  v_dot2_f32_bf16 v16, v81, v5, v16
  v_dot2_f32_bf16 v16, v82, v6, v16
  v_dot2_f32_bf16 v16, v83, v7, v16
  s_waitcnt vmcnt(26)
  v_dot2_f32_bf16 v17, v84, v4, 0
  v_dot2_f32_bf16 v17, v85, v5, v17
  v_dot2_f32_bf16 v17, v86, v6, v17
  v_dot2_f32_bf16 v17, v87, v7, v17
  s_waitcnt vmcnt(25)
  v_dot2_f32_bf16 v18, v88, v4, 0
  v_dot2_f32_bf16 v18, v89, v5, v18
  v_dot2_f32_bf16 v18, v90, v6, v18
  v_dot2_f32_bf16 v18, v91, v7, v18
  s_waitcnt vmcnt(24)
  v_dot2_f32_bf16 v19, v92, v4, 0
  v_dot2_f32_bf16 v19, v93, v5, v19
  v_dot2_f32_bf16 v19, v94, v6, v19
  v_dot2_f32_bf16 v19, v95, v7, v19
  v_add_f32_dpp v12, v12, v12 row_mirror row_mask:0xf bank_mask:0x3
  v_add_f32_dpp v13, v13, v13 row_mirror row_mask:0xf bank_mask:0x3
  v_add_f32_dpp v14, v14, v14 row_mirror row_mask:0xf bank_mask:0x3
  v_add_f32_dpp v15, v15, v15 row_mirror row_mask:0xf bank_mask:0x3
  v_add_f32_dpp v12, v16, v16 row_mirror row_mask:0xf bank_mask:0xc
  v_add_f32_dpp v13, v17, v17 row_mirror row_mask:0xf bank_mask:0xc
  v_add_f32_dpp v14, v18, v18 row_mirror row_mask:0xf bank_mask:0xc
  v_add_f32_dpp v15, v19, v19 row_mirror row_mask:0xf bank_mask:0xc
  v_add_f32_dpp v12, v12, v12 row_half_mirror row_mask:0xf bank_mask:0x5
  v_add_f32_dpp v13, v13, v13 row_half_mirror row_mask:0xf bank_mask:0x5
  s_nop 0
  v_add_f32_dpp v12, v14, v14 row_half_mirror row_mask:0xf bank_mask:0xa
  v_add_f32_dpp v13, v15, v15 row_half_mirror row_mask:0xf bank_mask:0xa
  s_nop 0
  v_add_f32_dpp v20, v12, v12 quad_perm:[2,3,0,1] row_mask:0xf bank_mask:0xf
  v_add_f32_dpp v21, v13, v13 quad_perm:[2,3,0,1] row_mask:0xf bank_mask:0xf
  v_cndmask_b32 v20, v20, v21, s[54:55]
  s_nop 1
  v_add_f32_dpp v20, v20, v20 quad_perm:[1,0,3,2] row_mask:0xf bank_mask:0xf
  v_mov_b32 v21, v20
  s_nop 1
  v_permlane16_swap_b32 v20, v21
  v_add_f32 v20, v20, v21
  v_cmp_gt_f32 vcc, v20, v22
  s_cbranch_vccnz L_slow2
L_back2:
  v_fma_f32 v21, v20, s48, -v23
  v_exp_f32 v25, v21
  s_nop 0
  v_add_f32 v24, v24, v25
  v_cvt_pk_bf16_f32 v25, v25, v25
  s_nop 1
  v_and_b32_dpp v32, v25, v8 row_newbcast:0 row_mask:0xf bank_mask:0xf
  v_and_b32_dpp v33, v25, v9 row_newbcast:0 row_mask:0xf bank_mask:0xf
  v_and_b32_dpp v34, v25, v10 row_newbcast:0 row_mask:0xf bank_mask:0xf
  v_and_b32_dpp v35, v25, v11 row_newbcast:0 row_mask:0xf bank_mask:0xf
  v_and_b32_dpp v36, v25, v8 row_newbcast:2 row_mask:0xf bank_mask:0xf
  v_and_b32_dpp v37, v25, v9 row_newbcast:2 row_mask:0xf bank_mask:0xf
  v_and_b32_dpp v38, v25, v10 row_newbcast:2 row_mask:0xf bank_mask:0xf
  v_and_b32_dpp v39, v25, v11 row_newbcast:2 row_mask:0xf bank_mask:0xf
  v_and_b32_dpp v40, v25, v8 row_newbcast:4 row_mask:0xf bank_mask:0xf
  v_and_b32_dpp v41, v25, v9 row_newbcast:4 row_mask:0xf bank_mask:0xf
  v_and_b32_dpp v42, v25, v10 row_newbcast:4 row_mask:0xf bank_mask:0xf
  v_and_b32_dpp v43, v25, v11 row_newbcast:4 row_mask:0xf bank_mask:0xf
  v_and_b32_dpp v44, v25, v8 row_newbcast:6 row_mask:0xf bank_mask:0xf
  v_and_b32_dpp v45, v25, v9 row_newbcast:6 row_mask:0xf bank_mask:0xf
  v_and_b32_dpp v46, v25, v10 row_newbcast:6 row_mask:0xf bank_mask:0xf
  v_and_b32_dpp v47, v25, v11 row_newbcast:6 row_mask:0xf bank_mask:0xf
  v_and_b32_dpp v48, v25, v8 row_newbcast:8 row_mask:0xf bank_mask:0xf
  v_and_b32_dpp v49, v25, v9 row_newbcast:8 row_mask:0xf bank_mask:0xf
  v_and_b32_dpp v50, v25, v10 row_newbcast:8 row_mask:0xf bank_mask:0xf
  v_and_b32_dpp v51, v25, v11 row_newbcast:8 row_mask:0xf bank_mask:0xf
  v_and_b32_dpp v52, v25, v8 row_newbcast:10 row_mask:0xf bank_mask:0xf
  v_and_b32_dpp v53, v25, v9 row_newbcast:10 row_mask:0xf bank_mask:0xf
  v_and_b32_dpp v54, v25, v10 row_newbcast:10 row_mask:0xf bank_mask:0xf
  v_and_b32_dpp v55, v25, v11 row_newbcast:10 row_mask:0xf bank_mask:0xf
  v_and_b32_dpp v56, v25, v8 row_newbcast:12 row_mask:0xf bank_mask:0xf
  v_and_b32_dpp v57, v25, v9 row_newbcast:12 row_mask:0xf bank_mask:0xf
  v_and_b32_dpp v58, v25, v10 row_newbcast:12 row_mask:0xf bank_mask:0xf
  v_and_b32_dpp v59, v25, v11 row_newbcast:12 row_mask:0xf bank_mask:0xf
  v_and_b32_dpp v60, v25, v8 row_newbcast:14 row_mask:0xf bank_mask:0xf
  v_and_b32_dpp v61, v25, v9 row_newbcast:14 row_mask:0xf bank_mask:0xf
  v_and_b32_dpp v62, v25, v10 row_newbcast:14 row_mask:0xf bank_mask:0xf
  v_and_b32_dpp v63, v25, v11 row_newbcast:14 row_mask:0xf bank_mask:0xf
  s_waitcnt vmcnt(23)
  v_mfma_f32_16x16x32_bf16 v[28:31], v[128:131], v[32:35], v[28:31]
  s_waitcnt vmcnt(22)
  v_mfma_f32_16x16x32_bf16 v[28:31], v[132:135], v[36:39], v[28:31]
  s_waitcnt vmcnt(21)
  v_mfma_f32_16x16x32_bf16 v[28:31], v[136:139], v[40:43], v[28:31]
  s_waitcnt vmcnt(20)
  v_mfma_f32_16x16x32_bf16 v[28:31], v[140:143], v[44:47], v[28:31]
  s_waitcnt vmcnt(19)
  v_mfma_f32_16x16x32_bf16 v[28:31], v[144:147], v[48:51], v[28:31]
  s_waitcnt vmcnt(18)
  v_mfma_f32_16x16x32_bf16 v[28:31], v[148:151], v[52:55], v[28:31]
  s_waitcnt vmcnt(17)
  v_mfma_f32_16x16x32_bf16 v[28:31], v[152:155], v[56:59], v[28:31]
  s_waitcnt vmcnt(16)
  v_mfma_f32_16x16x32_bf16 v[28:31], v[156:159], v[60:63], v[28:31]
  s_waitcnt vmcnt(15)
  v_dot2_f32_bf16 v12, v96, v4, 0
  v_dot2_f32_bf16 v12, v97, v5, v12
  v_dot2_f32_bf16 v12, v98, v6, v12
  v_dot2_f32_bf16 v12, v99, v7, v12
  s_waitcnt vmcnt(14)
  v_dot2_f32_bf16 v13, v100, v4, 0
  v_dot2_f32_bf16 v13, v101, v5, v13
  v_dot2_f32_bf16 v13, v102, v6, v13
  v_dot2_f32_bf16 v13, v103, v7, v13
  s_waitcnt vmcnt(13)
  v_dot2_f32_bf16 v14, v104, v4, 0
  v_dot2_f32_bf16 v14, v105, v5, v14
  v_dot2_f32_bf16 v14, v106, v6, v14
  v_dot2_f32_bf16 v14, v107, v7, v14
  s_waitcnt vmcnt(12)
  v_dot2_f32_bf16 v15, v108, v4, 0
  v_dot2_f32_bf16 v15, v109, v5, v15
  v_dot2_f32_bf16 v15, v110, v6, v15
  v_dot2_f32_bf16 v15, v111, v7, v15
  s_waitcnt vmcnt(11)
  v_dot2_f32_bf16 v16, v112, v4, 0
  v_dot2_f32_bf16 v16, v113, v5, v16
  v_dot2_f32_bf16 v16, v114, v6, v16
  v_dot2_f32_bf16 v16, v115, v7, v16
  s_waitcnt vmcnt(10)
  v_dot2_f32_bf16 v17, v116, v4, 0
  v_dot2_f32_bf16 v17, v117, v5, v17
  v_dot2_f32_bf16 v17, v118, v6, v17
  v_dot2_f32_bf16 v17, v119, v7, v17
  s_waitcnt vmcnt(9)
  v_dot2_f32_bf16 v18, v120, v4, 0
  v_dot2_f32_bf16 v18, v121, v5, v18
  v_dot2_f32_bf16 v18, v122, v6, v18
  v_dot2_f32_bf16 v18, v123, v7, v18
  s_waitcnt vmcnt(8)
  v_dot2_f32_bf16 v19, v124, v4, 0
  v_dot2_f32_bf16 v19, v125, v5, v19
  v_dot2_f32_bf16 v19, v126, v6, v19
  v_dot2_f32_bf16 v19, v127, v7, v19
  v_add_f32_dpp v12, v12, v12 row_mirror row_mask:0xf bank_mask:0x3
  v_add_f32_dpp v13, v13, v13 row_mirror row_mask:0xf bank_mask:0x3
  v_add_f32_dpp v14, v14, v14 row_mirror row_mask:0xf bank_mask:0x3
  v_add_f32_dpp v15, v15, v15 row_mirror row_mask:0xf bank_mask:0x3
  v_add_f32_dpp v12, v16, v16 row_mirror row_mask:0xf bank_mask:0xc
  v_add_f32_dpp v13, v17, v17 row_mirror row_mask:0xf bank_mask:0xc
  v_add_f32_dpp v14, v18, v18 row_mirror row_mask:0xf bank_mask:0xc
  v_add_f32_dpp v15, v19, v19 row_mirror row_mask:0xf bank_mask:0xc
  v_add_f32_dpp v12, v12, v12 row_half_mirror row_mask:0xf bank_mask:0x5
  v_add_f32_dpp v13, v13, v13 row_half_mirror row_mask:0xf bank_mask:0x5
  s_nop 0
  v_add_f32_dpp v12, v14, v14 row_half_mirror row_mask:0xf bank_mask:0xa
  v_add_f32_dpp v13, v15, v15 row_half_mirror row_mask:0xf bank_mask:0xa
  s_nop 0
  v_add_f32_dpp v20, v12, v12 quad_perm:[2,3,0,1] row_mask:0xf bank_mask:0xf
  v_add_f32_dpp v21, v13, v13 quad_perm:[2,3,0,1] row_mask:0xf bank_mask:0xf
  v_cndmask_b32 v20, v20, v21, s[54:55]
  s_nop 1
  v_add_f32_dpp v20, v20, v20 quad_perm:[1,0,3,2] row_mask:0xf bank_mask:0xf
  v_mov_b32 v21, v20
  s_nop 1
  v_permlane16_swap_b32 v20, v21
  v_add_f32 v20, v20, v21
  v_cmp_gt_f32 vcc, v20, v22
  s_cbranch_vccnz L_slow3
L_back3:
  v_fma_f32 v21, v20, s48, -v23
  v_exp_f32 v25, v21
  s_nop 0
  v_add_f32 v24, v24, v25
  v_cvt_pk_bf16_f32 v25, v25, v25
  s_nop 1
  v_and_b32_dpp v32, v25, v8 row_newbcast:0 row_mask:0xf bank_mask:0xf
  v_and_b32_dpp v33, v25, v9 row_newbcast:0 row_mask:0xf bank_mask:0xf
  v_and_b32_dpp v34, v25, v10 row_newbcast:0 row_mask:0xf bank_mask:0xf
  v_and_b32_dpp v35, v25, v11 row_newbcast:0 row_mask:0xf bank_mask:0xf
  v_and_b32_dpp v36, v25, v8 row_newbcast:2 row_mask:0xf bank_mask:0xf
  v_and_b32_dpp v37, v25, v9 row_newbcast:2 row_mask:0xf bank_mask:0xf
  v_and_b32_dpp v38, v25, v10 row_newbcast:2 row_mask:0xf bank_mask:0xf
  v_and_b32_dpp v39, v25, v11 row_newbcast:2 row_mask:0xf bank_mask:0xf
  v_and_b32_dpp v40, v25, v8 row_newbcast:4 row_mask:0xf bank_mask:0xf
  v_and_b32_dpp v41, v25, v9 row_newbcast:4 row_mask:0xf bank_mask:0xf
  v_and_b32_dpp v42, v25, v10 row_newbcast:4 row_mask:0xf bank_mask:0xf
  v_and_b32_dpp v43, v25, v11 row_newbcast:4 row_mask:0xf bank_mask:0xf
  v_and_b32_dpp v44, v25, v8 row_newbcast:6 row_mask:0xf bank_mask:0xf
  v_and_b32_dpp v45, v25, v9 row_newbcast:6 row_mask:0xf bank_mask:0xf
  v_and_b32_dpp v46, v25, v10 row_newbcast:6 row_mask:0xf bank_mask:0xf
  v_and_b32_dpp v47, v25, v11 row_newbcast:6 row_mask:0xf bank_mask:0xf
  v_and_b32_dpp v48, v25, v8 row_newbcast:8 row_mask:0xf bank_mask:0xf
  v_and_b32_dpp v49, v25, v9 row_newbcast:8 row_mask:0xf bank_mask:0xf
  v_and_b32_dpp v50, v25, v10 row_newbcast:8 row_mask:0xf bank_mask:0xf
  v_and_b32_dpp v51, v25, v11 row_newbcast:8 row_mask:0xf bank_mask:0xf
  v_and_b32_dpp v52, v25, v8 row_newbcast:10 row_mask:0xf bank_mask:0xf
  v_and_b32_dpp v53, v25, v9 row_newbcast:10 row_mask:0xf bank_mask:0xf
  v_and_b32_dpp v54, v25, v10 row_newbcast:10 row_mask:0xf bank_mask:0xf
  v_and_b32_dpp v55, v25, v11 row_newbcast:10 row_mask:0xf bank_mask:0xf
  v_and_b32_dpp v56, v25, v8 row_newbcast:12 row_mask:0xf bank_mask:0xf
  v_and_b32_dpp v57, v25, v9 row_newbcast:12 row_mask:0xf bank_mask:0xf
  v_and_b32_dpp v58, v25, v10 row_newbcast:12 row_mask:0xf bank_mask:0xf
  v_and_b32_dpp v59, v25, v11 row_newbcast:12 row_mask:0xf bank_mask:0xf
  v_and_b32_dpp v60, v25, v8 row_newbcast:14 row_mask:0xf bank_mask:0xf
  v_and_b32_dpp v61, v25, v9 row_newbcast:14 row_mask:0xf bank_mask:0xf
  v_and_b32_dpp v62, v25, v10 row_newbcast:14 row_mask:0xf bank_mask:0xf
  v_and_b32_dpp v63, v25, v11 row_newbcast:14 row_mask:0xf bank_mask:0xf
  v_add_f32_dpp v24, v24, v24 quad_perm:[2,3,0,1] row_mask:0xf bank_mask:0xf
  s_nop 1
  v_add_f32_dpp v24, v24, v24 row_half_mirror row_mask:0xf bank_mask:0xf
  s_nop 1
  v_add_f32_dpp v24, v24, v24 row_mirror row_mask:0xf bank_mask:0xf
  v_mov_b32 v21, v24
  s_nop 1
  v_permlane32_swap_b32 v24, v21
  v_add_f32 v24, v24, v21
  v_mov_b32 v12, v22
  v_mov_b32 v13, v24
  v_mov_b32 v14, v26
  v_mov_b32 v15, v26
  s_mov_b64 exec, 1
  buffer_store_dwordx4 v[12:15], v196, s[16:19], 0 offen sc1
  s_mov_b64 exec, -1
  s_waitcnt vmcnt(8)
  v_mfma_f32_16x16x32_bf16 v[28:31], v[160:163], v[32:35], v[28:31]
  s_waitcnt vmcnt(7)
  v_mfma_f32_16x16x32_bf16 v[28:31], v[164:167], v[36:39], v[28:31]
  s_waitcnt vmcnt(6)
  v_mfma_f32_16x16x32_bf16 v[28:31], v[168:171], v[40:43], v[28:31]
  s_waitcnt vmcnt(5)
  v_mfma_f32_16x16x32_bf16 v[28:31], v[172:175], v[44:47], v[28:31]
  s_waitcnt vmcnt(4)
  v_mfma_f32_16x16x32_bf16 v[28:31], v[176:179], v[48:51], v[28:31]
  s_waitcnt vmcnt(3)
  v_mfma_f32_16x16x32_bf16 v[28:31], v[180:183], v[52:55], v[28:31]
  s_waitcnt vmcnt(2)
  v_mfma_f32_16x16x32_bf16 v[28:31], v[184:187], v[56:59], v[28:31]
  s_waitcnt vmcnt(1)
  v_mfma_f32_16x16x32_bf16 v[28:31], v[188:191], v[60:63], v[28:31]
  s_branch L_fin
L_tail1:
  s_waitcnt vmcnt(31)
  v_dot2_f32_bf16 v12, v96, v4, 0
  v_dot2_f32_bf16 v12, v97, v5, v12
  v_dot2_f32_bf16 v12, v98, v6, v12
  v_dot2_f32_bf16 v12, v99, v7, v12
  s_waitcnt vmcnt(30)
  v_dot2_f32_bf16 v13, v100, v4, 0
  v_dot2_f32_bf16 v13, v101, v5, v13
  v_dot2_f32_bf16 v13, v102, v6, v13
  v_dot2_f32_bf16 v13, v103, v7, v13
  s_waitcnt vmcnt(29)
  v_dot2_f32_bf16 v14, v104, v4, 0
  v_dot2_f32_bf16 v14, v105, v5, v14
  v_dot2_f32_bf16 v14, v106, v6, v14
  v_dot2_f32_bf16 v14, v107, v7, v14
  s_waitcnt vmcnt(28)
  v_dot2_f32_bf16 v15, v108, v4, 0
  v_dot2_f32_bf16 v15, v109, v5, v15
  v_dot2_f32_bf16 v15, v110, v6, v15
  v_dot2_f32_bf16 v15, v111, v7, v15
  s_waitcnt vmcnt(27)
  v_dot2_f32_bf16 v16, v112, v4, 0
  v_dot2_f32_bf16 v16, v113, v5, v16
  v_dot2_f32_bf16 v16, v114, v6, v16
  v_dot2_f32_bf16 v16, v115, v7, v16
  s_waitcnt vmcnt(26)
  v_dot2_f32_bf16 v17, v116, v4, 0
  v_dot2_f32_bf16 v17, v117, v5, v17
  v_dot2_f32_bf16 v17, v118, v6, v17
  v_dot2_f32_bf16 v17, v119, v7, v17
  s_waitcnt vmcnt(25)
  v_dot2_f32_bf16 v18, v120, v4, 0
  v_dot2_f32_bf16 v18, v121, v5, v18
  v_dot2_f32_bf16 v18, v122, v6, v18
  v_dot2_f32_bf16 v18, v123, v7, v18
  s_waitcnt vmcnt(24)
  v_dot2_f32_bf16 v19, v124, v4, 0
  v_dot2_f32_bf16 v19, v125, v5, v19
  v_dot2_f32_bf16 v19, v126, v6, v19
  v_dot2_f32_bf16 v19, v127, v7, v19
  v_add_f32_dpp v12, v12, v12 row_mirror row_mask:0xf bank_mask:0x3
  v_add_f32_dpp v13, v13, v13 row_mirror row_mask:0xf bank_mask:0x3
  v_add_f32_dpp v14, v14, v14 row_mirror row_mask:0xf bank_mask:0x3
  v_add_f32_dpp v15, v15, v15 row_mirror row_mask:0xf bank_mask:0x3
  v_add_f32_dpp v12, v16, v16 row_mirror row_mask:0xf bank_mask:0xc
  v_add_f32_dpp v13, v17, v17 row_mirror row_mask:0xf bank_mask:0xc
  v_add_f32_dpp v14, v18, v18 row_mirror row_mask:0xf bank_mask:0xc
  v_add_f32_dpp v15, v19, v19 row_mirror row_mask:0xf bank_mask:0xc
  v_add_f32_dpp v12, v12, v12 row_half_mirror row_mask:0xf bank_mask:0x5
  v_add_f32_dpp v13, v13, v13 row_half_mirror row_mask:0xf bank_mask:0x5
  s_nop 0
  v_add_f32_dpp v12, v14, v14 row_half_mirror row_mask:0xf bank_mask:0xa
  v_add_f32_dpp v13, v15, v15 row_half_mirror row_mask:0xf bank_mask:0xa
  s_nop 0
  v_add_f32_dpp v20, v12, v12 quad_perm:[2,3,0,1] row_mask:0xf bank_mask:0xf
  v_add_f32_dpp v21, v13, v13 quad_perm:[2,3,0,1] row_mask:0xf bank_mask:0xf
  v_cndmask_b32 v20, v20, v21, s[54:55]
  s_nop 1
  v_add_f32_dpp v20, v20, v20 quad_perm:[1,0,3,2] row_mask:0xf bank_mask:0xf
  v_mov_b32 v21, v20
  s_nop 1
  v_permlane16_swap_b32 v20, v21
  v_add_f32 v20, v20, v21
  v_cmp_gt_f32 vcc, v20, v22
  s_cbranch_vccnz L_slow4
L_back4:
  v_fma_f32 v21, v20, s48, -v23
  v_exp_f32 v25, v21
  s_nop 0
  v_add_f32 v24, v24, v25
  v_cvt_pk_bf16_f32 v25, v25, v25
  s_nop 1
  v_and_b32_dpp v32, v25, v8 row_newbcast:0 row_mask:0xf bank_mask:0xf
  v_and_b32_dpp v33, v25, v9 row_newbcast:0 row_mask:0xf bank_mask:0xf
  v_and_b32_dpp v34, v25, v10 row_newbcast:0 row_mask:0xf bank_mask:0xf
  v_and_b32_dpp v35, v25, v11 row_newbcast:0 row_mask:0xf bank_mask:0xf
  v_and_b32_dpp v36, v25, v8 row_newbcast:2 row_mask:0xf bank_mask:0xf
  v_and_b32_dpp v37, v25, v9 row_newbcast:2 row_mask:0xf bank_mask:0xf
  v_and_b32_dpp v38, v25, v10 row_newbcast:2 row_mask:0xf bank_mask:0xf
  v_and_b32_dpp v39, v25, v11 row_newbcast:2 row_mask:0xf bank_mask:0xf
  v_and_b32_dpp v40, v25, v8 row_newbcast:4 row_mask:0xf bank_mask:0xf
  v_and_b32_dpp v41, v25, v9 row_newbcast:4 row_mask:0xf bank_mask:0xf
  v_and_b32_dpp v42, v25, v10 row_newbcast:4 row_mask:0xf bank_mask:0xf
  v_and_b32_dpp v43, v25, v11 row_newbcast:4 row_mask:0xf bank_mask:0xf
  v_and_b32_dpp v44, v25, v8 row_newbcast:6 row_mask:0xf bank_mask:0xf
  v_and_b32_dpp v45, v25, v9 row_newbcast:6 row_mask:0xf bank_mask:0xf
  v_and_b32_dpp v46, v25, v10 row_newbcast:6 row_mask:0xf bank_mask:0xf
  v_and_b32_dpp v47, v25, v11 row_newbcast:6 row_mask:0xf bank_mask:0xf
  v_and_b32_dpp v48, v25, v8 row_newbcast:8 row_mask:0xf bank_mask:0xf
  v_and_b32_dpp v49, v25, v9 row_newbcast:8 row_mask:0xf bank_mask:0xf
  v_and_b32_dpp v50, v25, v10 row_newbcast:8 row_mask:0xf bank_mask:0xf
  v_and_b32_dpp v51, v25, v11 row_newbcast:8 row_mask:0xf bank_mask:0xf
  v_and_b32_dpp v52, v25, v8 row_newbcast:10 row_mask:0xf bank_mask:0xf
  v_and_b32_dpp v53, v25, v9 row_newbcast:10 row_mask:0xf bank_mask:0xf
  v_and_b32_dpp v54, v25, v10 row_newbcast:10 row_mask:0xf bank_mask:0xf
  v_and_b32_dpp v55, v25, v11 row_newbcast:10 row_mask:0xf bank_mask:0xf
  v_and_b32_dpp v56, v25, v8 row_newbcast:12 row_mask:0xf bank_mask:0xf
  v_and_b32_dpp v57, v25, v9 row_newbcast:12 row_mask:0xf bank_mask:0xf
  v_and_b32_dpp v58, v25, v10 row_newbcast:12 row_mask:0xf bank_mask:0xf
  v_and_b32_dpp v59, v25, v11 row_newbcast:12 row_mask:0xf bank_mask:0xf
  v_and_b32_dpp v60, v25, v8 row_newbcast:14 row_mask:0xf bank_mask:0xf
  v_and_b32_dpp v61, v25, v9 row_newbcast:14 row_mask:0xf bank_mask:0xf
  v_and_b32_dpp v62, v25, v10 row_newbcast:14 row_mask:0xf bank_mask:0xf
  v_and_b32_dpp v63, v25, v11 row_newbcast:14 row_mask:0xf bank_mask:0xf
  s_waitcnt vmcnt(23)
  v_mfma_f32_16x16x32_bf16 v[28:31], v[160:163], v[32:35], v[28:31]
  s_waitcnt vmcnt(22)
  v_mfma_f32_16x16x32_bf16 v[28:31], v[164:167], v[36:39], v[28:31]
  s_waitcnt vmcnt(21)
  v_mfma_f32_16x16x32_bf16 v[28:31], v[168:171], v[40:43], v[28:31]
  s_waitcnt vmcnt(20)
  v_mfma_f32_16x16x32_bf16 v[28:31], v[172:175], v[44:47], v[28:31]
  s_waitcnt vmcnt(19)
  v_mfma_f32_16x16x32_bf16 v[28:31], v[176:179], v[48:51], v[28:31]
  s_waitcnt vmcnt(18)
  v_mfma_f32_16x16x32_bf16 v[28:31], v[180:183], v[52:55], v[28:31]
  s_waitcnt vmcnt(17)
  v_mfma_f32_16x16x32_bf16 v[28:31], v[184:187], v[56:59], v[28:31]
  s_waitcnt vmcnt(16)
  v_mfma_f32_16x16x32_bf16 v[28:31], v[188:191], v[60:63], v[28:31]
  s_waitcnt vmcnt(15)
  v_dot2_f32_bf16 v12, v64, v4, 0
  v_dot2_f32_bf16 v12, v65, v5, v12
  v_dot2_f32_bf16 v12, v66, v6, v12
  v_dot2_f32_bf16 v12, v67, v7, v12
  s_waitcnt vmcnt(14)
  v_dot2_f32_bf16 v13, v68, v4, 0
  v_dot2_f32_bf16 v13, v69, v5, v13
  v_dot2_f32_bf16 v13, v70, v6, v13
  v_dot2_f32_bf16 v13, v71, v7, v13
  s_waitcnt vmcnt(13)
  v_dot2_f32_bf16 v14, v72, v4, 0
  v_dot2_f32_bf16 v14, v73, v5, v14
  v_dot2_f32_bf16 v14, v74, v6, v14
  v_dot2_f32_bf16 v14, v75, v7, v14
  s_waitcnt vmcnt(12)
  v_dot2_f32_bf16 v15, v76, v4, 0
  v_dot2_f32_bf16 v15, v77, v5, v15
  v_dot2_f32_bf16 v15, v78, v6, v15
  v_dot2_f32_bf16 v15, v79, v7, v15
  s_waitcnt vmcnt(11)
  v_dot2_f32_bf16 v16, v80, v4, 0
  v_dot2_f32_bf16 v16, v81, v5, v16
  v_dot2_f32_bf16 v16, v82, v6, v16
  v_dot2_f32_bf16 v16, v83, v7, v16
  s_waitcnt vmcnt(10)
  v_dot2_f32_bf16 v17, v84, v4, 0
  v_dot2_f32_bf16 v17, v85, v5, v17
  v_dot2_f32_bf16 v17, v86, v6, v17
  v_dot2_f32_bf16 v17, v87, v7, v17
  s_waitcnt vmcnt(9)
  v_dot2_f32_bf16 v18, v88, v4, 0
  v_dot2_f32_bf16 v18, v89, v5, v18
  v_dot2_f32_bf16 v18, v90, v6, v18
  v_dot2_f32_bf16 v18, v91, v7, v18
  s_waitcnt vmcnt(8)
  v_dot2_f32_bf16 v19, v92, v4, 0
  v_dot2_f32_bf16 v19, v93, v5, v19
  v_dot2_f32_bf16 v19, v94, v6, v19
  v_dot2_f32_bf16 v19, v95, v7, v19
  v_add_f32_dpp v12, v12, v12 row_mirror row_mask:0xf bank_mask:0x3
  v_add_f32_dpp v13, v13, v13 row_mirror row_mask:0xf bank_mask:0x3
  v_add_f32_dpp v14, v14, v14 row_mirror row_mask:0xf bank_mask:0x3
  v_add_f32_dpp v15, v15, v15 row_mirror row_mask:0xf bank_mask:0x3
  v_add_f32_dpp v12, v16, v16 row_mirror row_mask:0xf bank_mask:0xc
  v_add_f32_dpp v13, v17, v17 row_mirror row_mask:0xf bank_mask:0xc
  v_add_f32_dpp v14, v18, v18 row_mirror row_mask:0xf bank_mask:0xc
  v_add_f32_dpp v15, v19, v19 row_mirror row_mask:0xf bank_mask:0xc
  v_add_f32_dpp v12, v12, v12 row_half_mirror row_mask:0xf bank_mask:0x5
  v_add_f32_dpp v13, v13, v13 row_half_mirror row_mask:0xf bank_mask:0x5
  s_nop 0
  v_add_f32_dpp v12, v14, v14 row_half_mirror row_mask:0xf bank_mask:0xa
  v_add_f32_dpp v13, v15, v15 row_half_mirror row_mask:0xf bank_mask:0xa
  s_nop 0
  v_add_f32_dpp v20, v12, v12 quad_perm:[2,3,0,1] row_mask:0xf bank_mask:0xf
  v_add_f32_dpp v21, v13, v13 quad_perm:[2,3,0,1] row_mask:0xf bank_mask:0xf
  v_cndmask_b32 v20, v20, v21, s[54:55]
  s_nop 1
  v_add_f32_dpp v20, v20, v20 quad_perm:[1,0,3,2] row_mask:0xf bank_mask:0xf
  v_mov_b32 v21, v20
  s_nop 1
  v_permlane16_swap_b32 v20, v21
  v_add_f32 v20, v20, v21
  v_cmp_gt_f32 vcc, v20, v22
  s_cbranch_vccnz L_slow5
L_back5:
  v_fma_f32 v21, v20, s48, -v23
  v_exp_f32 v25, v21
  s_nop 0
  v_add_f32 v24, v24, v25
  v_cvt_pk_bf16_f32 v25, v25, v25
  s_nop 1
  v_and_b32_dpp v32, v25, v8 row_newbcast:0 row_mask:0xf bank_mask:0xf
  v_and_b32_dpp v33, v25, v9 row_newbcast:0 row_mask:0xf bank_mask:0xf
  v_and_b32_dpp v34, v25, v10 row_newbcast:0 row_mask:0xf bank_mask:0xf
  v_and_b32_dpp v35, v25, v11 row_newbcast:0 row_mask:0xf bank_mask:0xf
  v_and_b32_dpp v36, v25, v8 row_newbcast:2 row_mask:0xf bank_mask:0xf
  v_and_b32_dpp v37, v25, v9 row_newbcast:2 row_mask:0xf bank_mask:0xf
  v_and_b32_dpp v38, v25, v10 row_newbcast:2 row_mask:0xf bank_mask:0xf
  v_and_b32_dpp v39, v25, v11 row_newbcast:2 row_mask:0xf bank_mask:0xf
  v_and_b32_dpp v40, v25, v8 row_newbcast:4 row_mask:0xf bank_mask:0xf
  v_and_b32_dpp v41, v25, v9 row_newbcast:4 row_mask:0xf bank_mask:0xf
  v_and_b32_dpp v42, v25, v10 row_newbcast:4 row_mask:0xf bank_mask:0xf
  v_and_b32_dpp v43, v25, v11 row_newbcast:4 row_mask:0xf bank_mask:0xf
  v_and_b32_dpp v44, v25, v8 row_newbcast:6 row_mask:0xf bank_mask:0xf
  v_and_b32_dpp v45, v25, v9 row_newbcast:6 row_mask:0xf bank_mask:0xf
  v_and_b32_dpp v46, v25, v10 row_newbcast:6 row_mask:0xf bank_mask:0xf
  v_and_b32_dpp v47, v25, v11 row_newbcast:6 row_mask:0xf bank_mask:0xf
  v_and_b32_dpp v48, v25, v8 row_newbcast:8 row_mask:0xf bank_mask:0xf
  v_and_b32_dpp v49, v25, v9 row_newbcast:8 row_mask:0xf bank_mask:0xf
  v_and_b32_dpp v50, v25, v10 row_newbcast:8 row_mask:0xf bank_mask:0xf
  v_and_b32_dpp v51, v25, v11 row_newbcast:8 row_mask:0xf bank_mask:0xf
  v_and_b32_dpp v52, v25, v8 row_newbcast:10 row_mask:0xf bank_mask:0xf
  v_and_b32_dpp v53, v25, v9 row_newbcast:10 row_mask:0xf bank_mask:0xf
  v_and_b32_dpp v54, v25, v10 row_newbcast:10 row_mask:0xf bank_mask:0xf
  v_and_b32_dpp v55, v25, v11 row_newbcast:10 row_mask:0xf bank_mask:0xf
  v_and_b32_dpp v56, v25, v8 row_newbcast:12 row_mask:0xf bank_mask:0xf
  v_and_b32_dpp v57, v25, v9 row_newbcast:12 row_mask:0xf bank_mask:0xf
  v_and_b32_dpp v58, v25, v10 row_newbcast:12 row_mask:0xf bank_mask:0xf
  v_and_b32_dpp v59, v25, v11 row_newbcast:12 row_mask:0xf bank_mask:0xf
  v_and_b32_dpp v60, v25, v8 row_newbcast:14 row_mask:0xf bank_mask:0xf
  v_and_b32_dpp v61, v25, v9 row_newbcast:14 row_mask:0xf bank_mask:0xf
  v_and_b32_dpp v62, v25, v10 row_newbcast:14 row_mask:0xf bank_mask:0xf
  v_and_b32_dpp v63, v25, v11 row_newbcast:14 row_mask:0xf bank_mask:0xf
  v_add_f32_dpp v24, v24, v24 quad_perm:[2,3,0,1] row_mask:0xf bank_mask:0xf
  s_nop 1
  v_add_f32_dpp v24, v24, v24 row_half_mirror row_mask:0xf bank_mask:0xf
  s_nop 1
  v_add_f32_dpp v24, v24, v24 row_mirror row_mask:0xf bank_mask:0xf
  v_mov_b32 v21, v24
  s_nop 1
  v_permlane32_swap_b32 v24, v21
  v_add_f32 v24, v24, v21
  v_mov_b32 v12, v22
  v_mov_b32 v13, v24
  v_mov_b32 v14, v26
  v_mov_b32 v15, v26
  s_mov_b64 exec, 1
  buffer_store_dwordx4 v[12:15], v196, s[16:19], 0 offen sc1
  s_mov_b64 exec, -1
  s_waitcnt vmcnt(8)
  v_mfma_f32_16x16x32_bf16 v[28:31], v[128:131], v[32:35], v[28:31]
  s_waitcnt vmcnt(7)
  v_mfma_f32_16x16x32_bf16 v[28:31], v[132:135], v[36:39], v[28:31]
  s_waitcnt vmcnt(6)
  v_mfma_f32_16x16x32_bf16 v[28:31], v[136:139], v[40:43], v[28:31]
  s_waitcnt vmcnt(5)
  v_mfma_f32_16x16x32_bf16 v[28:31], v[140:143], v[44:47], v[28:31]
  s_waitcnt vmcnt(4)
  v_mfma_f32_16x16x32_bf16 v[28:31], v[144:147], v[48:51], v[28:31]
  s_waitcnt vmcnt(3)
  v_mfma_f32_16x16x32_bf16 v[28:31], v[148:151], v[52:55], v[28:31]
  s_waitcnt vmcnt(2)
  v_mfma_f32_16x16x32_bf16 v[28:31], v[152:155], v[56:59], v[28:31]
  s_waitcnt vmcnt(1)
  v_mfma_f32_16x16x32_bf16 v[28:31], v[156:159], v[60:63], v[28:31]
L_fin:
  s_nop 7
  v_perm_b32 v29, v29, v26, s49
  v_perm_b32 v31, v31, v26, s49
  buffer_store_dwordx4 v[28:31], v195, s[16:19], 0 offen sc1
  s_barrier
  s_endpgm
L_slow0:
  v_mov_b32 v21, v20
  s_nop 1
  v_max_f32_dpp v21, v21, v21 quad_perm:[2,3,0,1] row_mask:0xf bank_mask:0xf
  s_nop 1
  v_max_f32_dpp v21, v21, v21 row_half_mirror row_mask:0xf bank_mask:0xf
  s_nop 1
  v_max_f32_dpp v21, v21, v21 row_mirror row_mask:0xf bank_mask:0xf
  v_mov_b32 v27, v21
  s_nop 1
  v_permlane32_swap_b32 v21, v27
  v_max_f32 v21, v21, v27
  v_max_f32 v21, v21, v22
  v_sub_f32 v27, v22, v21
  v_mul_f32 v27, s48, v27
  v_exp_f32 v27, v27
  v_mov_b32 v22, v21
  v_mul_f32 v23, s48, v21
  v_mul_f32 v24, v24, v27
  v_mul_f32 v28, v28, v27
  v_mul_f32 v29, v29, v27
  v_mul_f32 v30, v30, v27
  v_mul_f32 v31, v31, v27
  s_branch L_back0
L_slow1:
  v_mov_b32 v21, v20
  s_nop 1
  v_max_f32_dpp v21, v21, v21 quad_perm:[2,3,0,1] row_mask:0xf bank_mask:0xf
  s_nop 1
  v_max_f32_dpp v21, v21, v21 row_half_mirror row_mask:0xf bank_mask:0xf
  s_nop 1
  v_max_f32_dpp v21, v21, v21 row_mirror row_mask:0xf bank_mask:0xf
  v_mov_b32 v27, v21
  s_nop 1
  v_permlane32_swap_b32 v21, v27
  v_max_f32 v21, v21, v27
  v_max_f32 v21, v21, v22
  v_sub_f32 v27, v22, v21
  v_mul_f32 v27, s48, v27
  v_exp_f32 v27, v27
  v_mov_b32 v22, v21
  v_mul_f32 v23, s48, v21
  v_mul_f32 v24, v24, v27
  v_mul_f32 v28, v28, v27
  v_mul_f32 v29, v29, v27
  v_mul_f32 v30, v30, v27
  v_mul_f32 v31, v31, v27
  s_branch L_back1
L_slow2:
  v_mov_b32 v21, v20
  s_nop 1
  v_max_f32_dpp v21, v21, v21 quad_perm:[2,3,0,1] row_mask:0xf bank_mask:0xf
  s_nop 1
  v_max_f32_dpp v21, v21, v21 row_half_mirror row_mask:0xf bank_mask:0xf
  s_nop 1
  v_max_f32_dpp v21, v21, v21 row_mirror row_mask:0xf bank_mask:0xf
  v_mov_b32 v27, v21
  s_nop 1
  v_permlane32_swap_b32 v21, v27
  v_max_f32 v21, v21, v27
  v_max_f32 v21, v21, v22
  v_sub_f32 v27, v22, v21
  v_mul_f32 v27, s48, v27
  v_exp_f32 v27, v27
  v_mov_b32 v22, v21
  v_mul_f32 v23, s48, v21
  v_mul_f32 v24, v24, v27
  v_mul_f32 v28, v28, v27
  v_mul_f32 v29, v29, v27
  v_mul_f32 v30, v30, v27
  v_mul_f32 v31, v31, v27
  s_branch L_back2
L_slow3:
  v_mov_b32 v21, v20
  s_nop 1
  v_max_f32_dpp v21, v21, v21 quad_perm:[2,3,0,1] row_mask:0xf bank_mask:0xf
  s_nop 1
  v_max_f32_dpp v21, v21, v21 row_half_mirror row_mask:0xf bank_mask:0xf
  s_nop 1
  v_max_f32_dpp v21, v21, v21 row_mirror row_mask:0xf bank_mask:0xf
  v_mov_b32 v27, v21
  s_nop 1
  v_permlane32_swap_b32 v21, v27
  v_max_f32 v21, v21, v27
  v_max_f32 v21, v21, v22
  v_sub_f32 v27, v22, v21
  v_mul_f32 v27, s48, v27
  v_exp_f32 v27, v27
  v_mov_b32 v22, v21
  v_mul_f32 v23, s48, v21
  v_mul_f32 v24, v24, v27
  v_mul_f32 v28, v28, v27
  v_mul_f32 v29, v29, v27
  v_mul_f32 v30, v30, v27
  v_mul_f32 v31, v31, v27
  s_branch L_back3
L_slow4:
  v_mov_b32 v21, v20
  s_nop 1
  v_max_f32_dpp v21, v21, v21 quad_perm:[2,3,0,1] row_mask:0xf bank_mask:0xf
  s_nop 1
  v_max_f32_dpp v21, v21, v21 row_half_mirror row_mask:0xf bank_mask:0xf
  s_nop 1
  v_max_f32_dpp v21, v21, v21 row_mirror row_mask:0xf bank_mask:0xf
  v_mov_b32 v27, v21
  s_nop 1
  v_permlane32_swap_b32 v21, v27
  v_max_f32 v21, v21, v27
  v_max_f32 v21, v21, v22
  v_sub_f32 v27, v22, v21
  v_mul_f32 v27, s48, v27
  v_exp_f32 v27, v27
  v_mov_b32 v22, v21
  v_mul_f32 v23, s48, v21
  v_mul_f32 v24, v24, v27
  v_mul_f32 v28, v28, v27
  v_mul_f32 v29, v29, v27
  v_mul_f32 v30, v30, v27
  v_mul_f32 v31, v31, v27
  s_branch L_back4
L_slow5:
  v_mov_b32 v21, v20
  s_nop 1
  v_max_f32_dpp v21, v21, v21 quad_perm:[2,3,0,1] row_mask:0xf bank_mask:0xf
  s_nop 1
  v_max_f32_dpp v21, v21, v21 row_half_mirror row_mask:0xf bank_mask:0xf
  s_nop 1
  v_max_f32_dpp v21, v21, v21 row_mirror row_mask:0xf bank_mask:0xf
  v_mov_b32 v27, v21
  s_nop 1
  v_permlane32_swap_b32 v21, v27
  v_max_f32 v21, v21, v27
  v_max_f32 v21, v21, v22
  v_sub_f32 v27, v22, v21
  v_mul_f32 v27, s48, v27
  v_exp_f32 v27, v27
  v_mov_b32 v22, v21
  v_mul_f32 v23, s48, v21
  v_mul_f32 v24, v24, v27
  v_mul_f32 v28, v28, v27
  v_mul_f32 v29, v29, v27
  v_mul_f32 v30, v30, v27
  v_mul_f32 v31, v31, v27
  s_branch L_back5
L_helper:
  s_mov_b32 s18, 0x400000
  s_mov_b32 s19, 0x20000
  s_mov_b32 s22, 0xe00
  s_mov_b32 s23, 0x20000
  s_mov_b32 s26, 0x380000
  s_mov_b32 s27, 0x20000
  s_mov_b32 s30, 0x380000
  s_mov_b32 s31, 0x20000
  s_mov_b32 s34, 0xe00
  s_mov_b32 s35, 0x20000
  s_mov_b32 s48, 0x3db8aa3b
  s_mov_b32 s49, 0x07060500
  s_mov_b32 s50, 0xff
  s_mov_b32 s51, 0x400000
  s_lshl_b32 s41, s38, 2
  s_add_u32 s41, s41, s37
  s_mov_b32 s62, 0x1000
  s_mov_b32 s63, 0x2000
  s_mov_b32 s64, 0x3000
  s_mul_i32 s52, s36, 4352
  s_add_u32 s52, s52, 0x240000
  s_waitcnt lgkmcnt(0)
  s_and_b32 s17, s17, 0xffff
  s_and_b32 s21, s21, 0xffff
  s_and_b32 s25, s25, 0xffff
  s_and_b32 s29, s29, 0xffff
  s_and_b32 s33, s33, 0xffff
  s_cmp_lg_u32 s40, 0
  s_cbranch_scc1 L_hinit
  s_cmp_lg_u32 s37, 0
  s_cbranch_scc1 L_nocinit
  v_mov_b32 v8, 0
  s_mov_b64 exec, 1
  buffer_store_dword v8, off, s[16:19], s52 sc1
  s_mov_b64 exec, -1
L_nocinit:
  buffer_load_dword v6, off, s[16:19], 0 sc1
  s_mul_i32 s42, s41, 229376
  s_lshl_b32 s43, s39, 9
  s_add_u32 s42, s42, s43
  v_lshrrev_b32 v9, 5, v1
  v_and_b32 v10, 31, v1
  v_lshlrev_b32 v5, 13, v9
  v_lshl_add_u32 v5, v10, 4, v5
  v_add_u32 v5, s42, v5
  v_bfe_u32 v2, v1, 3, 2
  s_mul_i32 s42, s41, 56
  v_mul_u32_u24 v4, 896, v2
  v_add_u32 v4, s42, v4
  buffer_load_dwordx4 v[192:195], v4, s[20:23], 0 offen offset:0 nt
  buffer_load_dwordx4 v[196:199], v4, s[20:23], 0 offen offset:16 nt
  buffer_load_dwordx4 v[200:203], v4, s[20:23], 0 offen offset:32 nt
  buffer_load_dwordx2 v[204:205], v4, s[20:23], 0 offen offset:48 nt
  s_mov_b32 s43, 0
  buffer_load_dwordx4 v[64:67], v5, s[24:27], s43 offen nt
  s_add_u32 s43, s43, 0x4000
  buffer_load_dwordx4 v[68:71], v5, s[24:27], s43 offen nt
  s_add_u32 s43, s43, 0x4000
  buffer_load_dwordx4 v[72:75], v5, s[24:27], s43 offen nt
  s_add_u32 s43, s43, 0x4000
  buffer_load_dwordx4 v[76:79], v5, s[24:27], s43 offen nt
  s_add_u32 s43, s43, 0x4000
  buffer_load_dwordx4 v[80:83], v5, s[24:27], s43 offen nt
  s_add_u32 s43, s43, 0x4000
  buffer_load_dwordx4 v[84:87], v5, s[24:27], s43 offen nt
  s_add_u32 s43, s43, 0x4000
  buffer_load_dwordx4 v[88:91], v5, s[24:27], s43 offen nt
  s_add_u32 s43, s43, 0x4000
  buffer_load_dwordx4 v[92:95], v5, s[24:27], s43 offen nt
  s_add_u32 s43, s43, 0x4000
  buffer_load_dwordx4 v[96:99], v5, s[24:27], s43 offen nt
  s_add_u32 s43, s43, 0x4000
  buffer_load_dwordx4 v[100:103], v5, s[24:27], s43 offen nt
  s_add_u32 s43, s43, 0x4000
  buffer_load_dwordx4 v[104:107], v5, s[24:27], s43 offen nt
  s_add_u32 s43, s43, 0x4000
  buffer_load_dwordx4 v[108:111], v5, s[24:27], s43 offen nt
  s_add_u32 s43, s43, 0x4000
  buffer_load_dwordx4 v[112:115], v5, s[24:27], s43 offen nt
  s_add_u32 s43, s43, 0x4000
  buffer_load_dwordx4 v[116:119], v5, s[24:27], s43 offen nt
  v_mov_b32 v10, 0x0100
  v_mov_b32 v8, 0x0302
  v_cmp_ne_u32 vcc, 0, v9
  s_nop 1
  v_cndmask_b32 v9, v10, v8, vcc
  v_or_b32 v10, 0x0c0c0000, v9
  v_lshlrev_b32 v9, 16, v9
  v_or_b32 v9, 0x0c0c, v9
  v_and_b32 v8, 1, v1
  v_cmp_ne_u32 vcc, 0, v8
  s_nop 1
  v_cndmask_b32 v9, v10, v9, vcc
  v_bfe_u32 v10, v1, 1, 2
  v_mov_b32 v8, 0x0c0c0c0c
  v_cmp_eq_u32 s[56:57], 0, v10
  v_cmp_eq_u32 s[58:59], 1, v10
  v_cmp_eq_u32 s[60:61], 2, v10
  v_cmp_eq_u32 vcc, 3, v10
  v_cndmask_b32 v12, v8, v9, s[56:57]
  v_cndmask_b32 v13, v8, v9, s[58:59]
  v_cndmask_b32 v14, v8, v9, s[60:61]
  v_cndmask_b32 v15, v8, v9, vcc
  s_lshl_b32 s42, s39, 14
  s_lshl_b32 s43, s41, 10
  s_add_u32 s42, s42, s43
  s_add_u32 s42, s42, 0x10000
  v_bfe_u32 v63, v1, 3, 2
  v_lshlrev_b32 v63, 18, v63
  v_lshrrev_b32 v8, 5, v1
  v_lshl_add_u32 v63, v8, 7, v63
  v_and_b32 v8, 7, v1
  v_lshl_add_u32 v63, v8, 4, v63
  v_add_u32 v63, s42, v63
  s_lshl_b32 s42, s36, 14
  s_add_u32 s42, s42, 0x10000
  v_lshl_add_u32 v5, v1, 4, s42
  v_and_b32 v9, 15, v1
  v_lshlrev_b32 v9, 10, v9
  s_add_u32 s42, s42, 1020
  v_add_u32 v56, s42, v9
  v_mov_b32 v208, 0
  v_mov_b32 v209, 0
  v_mov_b32 v210, 0
  v_mov_b32 v211, 0
  v_mov_b32 v212, 0
  v_mov_b32 v213, 0
  v_mov_b32 v214, 0
  v_mov_b32 v215, 0
  v_mov_b32 v216, 0
  v_mov_b32 v217, 0
  v_mov_b32 v218, 0
  v_mov_b32 v219, 0
  v_mov_b32 v220, 0
  v_mov_b32 v221, 0
  v_mov_b32 v222, 0
  v_mov_b32 v223, 0
  s_waitcnt vmcnt(14)
  v_add_u32 v6, 1, v6
  v_and_b32 v60, s50, v6
  v_perm_b32 v20, v192, v192, v12
  v_perm_b32 v21, v192, v192, v13
  v_perm_b32 v22, v192, v192, v14
  v_perm_b32 v23, v192, v192, v15
  s_waitcnt vmcnt(13)
  s_nop 0
  v_mfma_f32_32x32x16_bf16 v[208:223], v[64:67], v[20:23], v[208:223]
  v_perm_b32 v24, v193, v193, v12
  v_perm_b32 v25, v193, v193, v13
  v_perm_b32 v26, v193, v193, v14
  v_perm_b32 v27, v193, v193, v15
  s_waitcnt vmcnt(12)
  s_nop 0
  v_mfma_f32_32x32x16_bf16 v[208:223], v[68:71], v[24:27], v[208:223]
  v_perm_b32 v20, v194, v194, v12
  v_perm_b32 v21, v194, v194, v13
  v_perm_b32 v22, v194, v194, v14
  v_perm_b32 v23, v194, v194, v15
  s_waitcnt vmcnt(11)
  s_nop 0
  v_mfma_f32_32x32x16_bf16 v[208:223], v[72:75], v[20:23], v[208:223]
  v_perm_b32 v24, v195, v195, v12
  v_perm_b32 v25, v195, v195, v13
  v_perm_b32 v26, v195, v195, v14
  v_perm_b32 v27, v195, v195, v15
  s_waitcnt vmcnt(10)
  s_nop 0
  v_mfma_f32_32x32x16_bf16 v[208:223], v[76:79], v[24:27], v[208:223]
  v_perm_b32 v20, v196, v196, v12
  v_perm_b32 v21, v196, v196, v13
  v_perm_b32 v22, v196, v196, v14
  v_perm_b32 v23, v196, v196, v15
  s_waitcnt vmcnt(9)
  s_nop 0
  v_mfma_f32_32x32x16_bf16 v[208:223], v[80:83], v[20:23], v[208:223]
  v_perm_b32 v24, v197, v197, v12
  v_perm_b32 v25, v197, v197, v13
  v_perm_b32 v26, v197, v197, v14
  v_perm_b32 v27, v197, v197, v15
  s_waitcnt vmcnt(8)
  s_nop 0
  v_mfma_f32_32x32x16_bf16 v[208:223], v[84:87], v[24:27], v[208:223]
  v_perm_b32 v20, v198, v198, v12
  v_perm_b32 v21, v198, v198, v13
  v_perm_b32 v22, v198, v198, v14
  v_perm_b32 v23, v198, v198, v15
  s_waitcnt vmcnt(7)
  s_nop 0
  v_mfma_f32_32x32x16_bf16 v[208:223], v[88:91], v[20:23], v[208:223]
  v_perm_b32 v24, v199, v199, v12
  v_perm_b32 v25, v199, v199, v13
  v_perm_b32 v26, v199, v199, v14
  v_perm_b32 v27, v199, v199, v15
  s_waitcnt vmcnt(6)
  s_nop 0
  v_mfma_f32_32x32x16_bf16 v[208:223], v[92:95], v[24:27], v[208:223]
  v_perm_b32 v20, v200, v200, v12
  v_perm_b32 v21, v200, v200, v13
  v_perm_b32 v22, v200, v200, v14
  v_perm_b32 v23, v200, v200, v15
  s_waitcnt vmcnt(5)
  s_nop 0
  v_mfma_f32_32x32x16_bf16 v[208:223], v[96:99], v[20:23], v[208:223]
  v_perm_b32 v24, v201, v201, v12
  v_perm_b32 v25, v201, v201, v13
  v_perm_b32 v26, v201, v201, v14
  v_perm_b32 v27, v201, v201, v15
  s_waitcnt vmcnt(4)
  s_nop 0
  v_mfma_f32_32x32x16_bf16 v[208:223], v[100:103], v[24:27], v[208:223]
  v_perm_b32 v20, v202, v202, v12
  v_perm_b32 v21, v202, v202, v13
  v_perm_b32 v22, v202, v202, v14
  v_perm_b32 v23, v202, v202, v15
  s_waitcnt vmcnt(3)
  s_nop 0
  v_mfma_f32_32x32x16_bf16 v[208:223], v[104:107], v[20:23], v[208:223]
  v_perm_b32 v24, v203, v203, v12
  v_perm_b32 v25, v203, v203, v13
  v_perm_b32 v26, v203, v203, v14
  v_perm_b32 v27, v203, v203, v15
  s_waitcnt vmcnt(2)
  s_nop 0
  v_mfma_f32_32x32x16_bf16 v[208:223], v[108:111], v[24:27], v[208:223]
  v_perm_b32 v20, v204, v204, v12
  v_perm_b32 v21, v204, v204, v13
  v_perm_b32 v22, v204, v204, v14
  v_perm_b32 v23, v204, v204, v15
  s_waitcnt vmcnt(1)
  s_nop 0
  v_mfma_f32_32x32x16_bf16 v[208:223], v[112:115], v[20:23], v[208:223]
  v_perm_b32 v24, v205, v205, v12
  v_perm_b32 v25, v205, v205, v13
  v_perm_b32 v26, v205, v205, v14
  v_perm_b32 v27, v205, v205, v15
  s_waitcnt vmcnt(0)
  s_nop 0
  v_mfma_f32_32x32x16_bf16 v[208:223], v[116:119], v[24:27], v[208:223]
  s_nop 11
  v_perm_b32 v209, v209, v6, s49
  v_perm_b32 v211, v211, v6, s49
  buffer_store_dwordx4 v[208:211], v63, s[16:19], 0 offen offset:0 sc1
  v_perm_b32 v213, v213, v6, s49
  v_perm_b32 v215, v215, v6, s49
  buffer_store_dwordx4 v[212:215], v63, s[16:19], 0 offen offset:256 sc1
  v_perm_b32 v217, v217, v6, s49
  v_perm_b32 v219, v219, v6, s49
  buffer_store_dwordx4 v[216:219], v63, s[16:19], 0 offen offset:512 sc1
  v_perm_b32 v221, v221, v6, s49
  v_perm_b32 v223, v223, v6, s49
  buffer_store_dwordx4 v[220:223], v63, s[16:19], 0 offen offset:768 sc1
  s_waitcnt vmcnt(0)
  s_branch L_pollq
L_flagq:
  buffer_load_dword v9, v56, s[16:19], 0 offen sc1
  s_waitcnt vmcnt(0)
  v_xor_b32 v9, v9, v60
  v_and_b32 v9, s50, v9
  v_cmp_ne_u32 vcc, 0, v9
  s_cbranch_vccz L_pollq
  s_sub_u32 s51, s51, 16
  s_cbranch_scc0 L_flagq
L_pollq:
  buffer_load_dwordx4 v[64:67], v5, s[16:19], 0 offen offset:0 sc1
  buffer_load_dwordx4 v[68:71], v5, s[16:19], 0 offen offset:1024 sc1
  buffer_load_dwordx4 v[72:75], v5, s[16:19], 0 offen offset:2048 sc1
  buffer_load_dwordx4 v[76:79], v5, s[16:19], 0 offen offset:3072 sc1
  buffer_load_dwordx4 v[80:83], v5, s[16:19], s62 offen offset:0 sc1
  buffer_load_dwordx4 v[84:87], v5, s[16:19], s62 offen offset:1024 sc1
  buffer_load_dwordx4 v[88:91], v5, s[16:19], s62 offen offset:2048 sc1
  buffer_load_dwordx4 v[92:95], v5, s[16:19], s62 offen offset:3072 sc1
  buffer_load_dwordx4 v[96:99], v5, s[16:19], s63 offen offset:0 sc1
  buffer_load_dwordx4 v[100:103], v5, s[16:19], s63 offen offset:1024 sc1
  buffer_load_dwordx4 v[104:107], v5, s[16:19], s63 offen offset:2048 sc1
  buffer_load_dwordx4 v[108:111], v5, s[16:19], s63 offen offset:3072 sc1
  buffer_load_dwordx4 v[112:115], v5, s[16:19], s64 offen offset:0 sc1
  buffer_load_dwordx4 v[116:119], v5, s[16:19], s64 offen offset:1024 sc1
  buffer_load_dwordx4 v[120:123], v5, s[16:19], s64 offen offset:2048 sc1
  buffer_load_dwordx4 v[124:127], v5, s[16:19], s64 offen offset:3072 sc1
  s_waitcnt vmcnt(0)
  v_xor_b32 v65, v65, v60
  v_xor_b32 v67, v67, v60
  v_or_b32 v8, v65, v67
  v_xor_b32 v69, v69, v60
  v_xor_b32 v71, v71, v60
  v_or3_b32 v8, v8, v69, v71
  v_xor_b32 v73, v73, v60
  v_xor_b32 v75, v75, v60
  v_or3_b32 v8, v8, v73, v75
  v_xor_b32 v77, v77, v60
  v_xor_b32 v79, v79, v60
  v_or3_b32 v8, v8, v77, v79
  v_xor_b32 v81, v81, v60
  v_xor_b32 v83, v83, v60
  v_or3_b32 v8, v8, v81, v83
  v_xor_b32 v85, v85, v60
  v_xor_b32 v87, v87, v60
  v_or3_b32 v8, v8, v85, v87
  v_xor_b32 v89, v89, v60
  v_xor_b32 v91, v91, v60
  v_or3_b32 v8, v8, v89, v91
  v_xor_b32 v93, v93, v60
  v_xor_b32 v95, v95, v60
  v_or3_b32 v8, v8, v93, v95
  v_xor_b32 v97, v97, v60
  v_xor_b32 v99, v99, v60
  v_or3_b32 v8, v8, v97, v99
  v_xor_b32 v101, v101, v60
  v_xor_b32 v103, v103, v60
  v_or3_b32 v8, v8, v101, v103
  v_xor_b32 v105, v105, v60
  v_xor_b32 v107, v107, v60
  v_or3_b32 v8, v8, v105, v107
  v_xor_b32 v109, v109, v60
  v_xor_b32 v111, v111, v60
  v_or3_b32 v8, v8, v109, v111
  v_xor_b32 v113, v113, v60
  v_xor_b32 v115, v115, v60
  v_or3_b32 v8, v8, v113, v115
  v_xor_b32 v117, v117, v60
  v_xor_b32 v119, v119, v60
  v_or3_b32 v8, v8, v117, v119
  v_xor_b32 v121, v121, v60
  v_xor_b32 v123, v123, v60
  v_or3_b32 v8, v8, v121, v123
  v_xor_b32 v125, v125, v60
  v_xor_b32 v127, v127, v60
  v_or3_b32 v8, v8, v125, v127
  v_and_b32 v8, s50, v8
  v_cmp_ne_u32 vcc, 0, v8
  s_cbranch_vccz L_gotq
  s_sub_u32 s51, s51, 16
  s_cbranch_scc0 L_pollq
L_gotq:
  v_add_f32 v64, v64, v96
  v_add_f32 v65, v65, v97
  v_add_f32 v66, v66, v98
  v_add_f32 v67, v67, v99
  v_add_f32 v68, v68, v100
  v_add_f32 v69, v69, v101
  v_add_f32 v70, v70, v102
  v_add_f32 v71, v71, v103
  v_add_f32 v72, v72, v104
  v_add_f32 v73, v73, v105
  v_add_f32 v74, v74, v106
  v_add_f32 v75, v75, v107
  v_add_f32 v76, v76, v108
  v_add_f32 v77, v77, v109
  v_add_f32 v78, v78, v110
  v_add_f32 v79, v79, v111
  v_add_f32 v80, v80, v112
  v_add_f32 v81, v81, v113
  v_add_f32 v82, v82, v114
  v_add_f32 v83, v83, v115
  v_add_f32 v84, v84, v116
  v_add_f32 v85, v85, v117
  v_add_f32 v86, v86, v118
  v_add_f32 v87, v87, v119
  v_add_f32 v88, v88, v120
  v_add_f32 v89, v89, v121
  v_add_f32 v90, v90, v122
  v_add_f32 v91, v91, v123
  v_add_f32 v92, v92, v124
  v_add_f32 v93, v93, v125
  v_add_f32 v94, v94, v126
  v_add_f32 v95, v95, v127
  v_add_f32 v64, v64, v80
  v_add_f32 v65, v65, v81
  v_add_f32 v66, v66, v82
  v_add_f32 v67, v67, v83
  v_add_f32 v68, v68, v84
  v_add_f32 v69, v69, v85
  v_add_f32 v70, v70, v86
  v_add_f32 v71, v71, v87
  v_add_f32 v72, v72, v88
  v_add_f32 v73, v73, v89
  v_add_f32 v74, v74, v90
  v_add_f32 v75, v75, v91
  v_add_f32 v76, v76, v92
  v_add_f32 v77, v77, v93
  v_add_f32 v78, v78, v94
  v_add_f32 v79, v79, v95
  v_add_f32 v64, v64, v72
  v_add_f32 v65, v65, v73
  v_add_f32 v66, v66, v74
  v_add_f32 v67, v67, v75
  v_add_f32 v68, v68, v76
  v_add_f32 v69, v69, v77
  v_add_f32 v70, v70, v78
  v_add_f32 v71, v71, v79
  v_add_f32 v64, v64, v68
  v_add_f32 v65, v65, v69
  v_add_f32 v66, v66, v70
  v_add_f32 v67, v67, v71
  v_lshrrev_b32 v9, 3, v1
  v_lshlrev_b32 v9, 5, v9
  v_and_b32 v10, 7, v1
  v_add_lshl_u32 v9, v9, v10, 1
  v_cvt_pk_bf16_f32 v64, v64, v64
  v_cvt_pk_bf16_f32 v65, v65, v65
  v_cvt_pk_bf16_f32 v66, v66, v66
  v_cvt_pk_bf16_f32 v67, v67, v67
  ds_write_b16 v9, v64 offset:0
  ds_write_b16 v9, v65 offset:16
  ds_write_b16 v9, v66 offset:32
  ds_write_b16 v9, v67 offset:48
  v_mov_b32 v10, 512
  ds_write_b32 v10, v6
L_hinit:
  s_lshl_b32 s42, s40, 10
  s_add_u32 s42, s42, 1024
  v_lshl_add_u32 v62, v1, 2, s42
  v_mov_b32 v9, -1
  ds_write_b32 v62, v9 offset:0
  ds_write_b32 v62, v9 offset:256
  ds_write_b32 v62, v9 offset:512
  ds_write_b32 v62, v9 offset:768
  s_lshl_b32 s43, s40, 2
  s_add_u32 s43, s43, 544
  v_mov_b32 v61, s43
  v_mov_b32 v10, 0
  ds_write_b32 v61, v10
  v_mov_b32 v62, s42
  s_waitcnt lgkmcnt(0)
  s_barrier
  v_mov_b32 v10, 512
  ds_read_b32 v6, v10
  v_and_b32 v2, 15, v1
  v_lshrrev_b32 v3, 4, v1
  s_lshl_b32 s42, s39, 8
  s_lshl_b32 s43, s40, 5
  s_add_u32 s42, s42, s43
  s_mul_i32 s42, s42, 896
  s_mul_i32 s43, s37, 256
  s_add_u32 s42, s42, s43
  v_mul_u32_u24 v4, 7168, v3
  v_lshl_add_u32 v4, v2, 4, v4
  v_add_u32 v4, s42, v4
  v_lshl_add_u32 v9, v2, 4, s43
  v_mov_b32 v10, 0x80000000
  v_cmp_gt_u32 vcc, 0x380, v9
  s_nop 1
  v_cndmask_b32 v4, v10, v4, vcc
  s_mov_b32 s43, 0
  buffer_load_dwordx4 v[128:131], v4, s[28:31], s43 offen nt
  s_mov_b32 s43, 896
  s_waitcnt vmcnt(0)
  buffer_load_dwordx4 v[132:135], v4, s[28:31], s43 offen nt
  s_mov_b32 s43, 1792
  s_waitcnt vmcnt(0)
  buffer_load_dwordx4 v[136:139], v4, s[28:31], s43 offen nt
  s_mov_b32 s43, 2688
  s_waitcnt vmcnt(0)
  buffer_load_dwordx4 v[140:143], v4, s[28:31], s43 offen nt
  s_mov_b32 s43, 3584
  s_waitcnt vmcnt(0)
  buffer_load_dwordx4 v[144:147], v4, s[28:31], s43 offen nt
  s_mov_b32 s43, 4480
  s_waitcnt vmcnt(0)
  buffer_load_dwordx4 v[148:151], v4, s[28:31], s43 offen nt
  s_mov_b32 s43, 5376
  s_waitcnt vmcnt(0)
  buffer_load_dwordx4 v[152:155], v4, s[28:31], s43 offen nt
  s_mov_b32 s43, 6272
  s_waitcnt vmcnt(0)
  buffer_load_dwordx4 v[156:159], v4, s[28:31], s43 offen nt
  s_mov_b32 s43, 114688
  s_waitcnt vmcnt(0)
  buffer_load_dwordx4 v[160:163], v4, s[28:31], s43 offen nt
  s_mov_b32 s43, 115584
  s_waitcnt vmcnt(0)
  buffer_load_dwordx4 v[164:167], v4, s[28:31], s43 offen nt
  s_mov_b32 s43, 116480
  s_waitcnt vmcnt(0)
  buffer_load_dwordx4 v[168:171], v4, s[28:31], s43 offen nt
  s_mov_b32 s43, 117376
  s_waitcnt vmcnt(0)
  buffer_load_dwordx4 v[172:175], v4, s[28:31], s43 offen nt
  s_mov_b32 s43, 118272
  s_waitcnt vmcnt(0)
  buffer_load_dwordx4 v[176:179], v4, s[28:31], s43 offen nt
  s_mov_b32 s43, 119168
  s_waitcnt vmcnt(0)
  buffer_load_dwordx4 v[180:183], v4, s[28:31], s43 offen nt
  s_mov_b32 s43, 120064
  s_waitcnt vmcnt(0)
  buffer_load_dwordx4 v[184:187], v4, s[28:31], s43 offen nt
  s_mov_b32 s43, 120960
  s_waitcnt vmcnt(0)
  buffer_load_dwordx4 v[188:191], v4, s[28:31], s43 offen nt
  v_and_b32 v9, 1, v1
  v_lshlrev_b32 v9, 4, v9
  v_mov_b32 v10, 0xffff
  v_lshlrev_b32 v9, v9, v10
  v_bfe_u32 v10, v1, 1, 3
  v_cmp_eq_u32 s[56:57], 0, v10
  v_cmp_eq_u32 s[58:59], 1, v10
  v_cmp_eq_u32 s[60:61], 2, v10
  v_cmp_eq_u32 vcc, 3, v10
  v_cndmask_b32 v52, 0, v9, s[56:57]
  v_cndmask_b32 v53, 0, v9, s[58:59]
  v_cndmask_b32 v54, 0, v9, s[60:61]
  v_cndmask_b32 v55, 0, v9, vcc
  s_waitcnt lgkmcnt(0)
  v_and_b32 v60, s50, v6
  s_lshl_b32 s42, s36, 14
  s_lshl_b32 s43, s40, 8
  s_add_u32 s42, s42, s43
  s_add_u32 s42, s42, 0x110000
  v_lshlrev_b32 v5, 10, v3
  v_lshl_add_u32 v5, v2, 4, v5
  v_add_u32 v5, s42, v5
  v_and_b32 v9, 3, v2
  v_lshlrev_b32 v9, 6, v9
  v_lshl_add_u32 v9, v3, 4, v9
  s_lshl_b32 s42, s36, 8
  s_add_u32 s42, s42, 0x210000
  v_add_u32 v57, s42, v9
  s_lshl_b32 s42, s41, 4
  s_add_u32 s42, s42, s39
  s_lshl_b32 s42, s42, 9
  s_add_u32 s42, s42, 0x220000
  v_lshlrev_b32 v9, 7, v3
  v_lshl_add_u32 v9, v2, 4, v9
  v_add_u32 v9, s42, v9
  v_mov_b32 v10, 0x80000000
  v_cmp_gt_u32 vcc, 8, v2
  s_nop 1
  v_cndmask_b32 v58, v10, v9, vcc
  s_lshl_b32 s42, s40, 10
  s_add_u32 s42, s42, 5120
  v_lshl_add_u32 v59, v1, 4, s42
  v_mov_b32 v16, 0
  v_mov_b32 v17, 0
  v_mov_b32 v18, 0
  v_mov_b32 v19, 0
  s_waitcnt vmcnt(0)
  s_cmp_lg_u32 s40, 0
  s_cbranch_scc1 L_served
  s_mov_b32 s65, 0
  v_lshlrev_b32 v62, 10, v1
  v_add_u32 v62, 1024, v62
L_serve:
  ds_read_b128 v[32:35], v61
  s_waitcnt lgkmcnt(0)
  v_max3_u32 v9, v32, v33, v34
  v_max_u32 v9, v9, v35
  s_nop 0
  v_readfirstlane_b32 s42, v9
  s_add_u32 s43, s65, 26
  s_cmp_gt_u32 s42, s43
  s_cbranch_scc1 L_claim
  s_sub_u32 s51, s51, 1
  s_cbranch_scc0 L_serve
  s_branch L_served
L_claim:
  v_mov_b32 v10, 4
  s_mov_b64 exec, 1
  buffer_atomic_add v10, off, s[16:19], s52 sc0 sc1
  s_mov_b64 exec, -1
  s_waitcnt vmcnt(0)
  v_readfirstlane_b32 s42, v10
  s_add_u32 s42, s42, 432
  s_cmp_ge_u32 s42, 512
  s_cselect_b32 s43, 0x80000000, 0
  s_cmp_ge_u32 s42, 500
  s_cselect_b32 s47, 1, 0
  s_or_b32 s43, s43, s47
  v_add_u32 v10, s42, v1
  v_lshl_or_b32 v10, v10, 13, s43
  s_lshl_b32 s47, s65, 2
  v_add_u32 v9, s47, v62
  s_mov_b64 exec, 15
  ds_write_b32 v9, v10
  s_mov_b64 exec, -1
  s_add_u32 s65, s65, 1
  s_cmp_lt_u32 s42, 508
  s_cbranch_scc1 L_serve
  s_cmp_ge_u32 s42, 512
  s_cbranch_scc1 L_served
  v_add_u32 v9, 4, v9
  v_mov_b32 v10, 0x80000000
  s_mov_b64 exec, 15
  ds_write_b32 v9, v10
  s_mov_b64 exec, -1
L_served:
  s_waitcnt lgkmcnt(0)
  s_barrier
L_pollo:
  buffer_load_dwordx4 v[32:35], v5, s[16:19], 0 offen sc1
  buffer_load_dwordx4 v[36:39], v5, s[16:19], s62 offen sc1
  buffer_load_dwordx4 v[40:43], v5, s[16:19], s63 offen sc1
  buffer_load_dwordx4 v[44:47], v5, s[16:19], s64 offen sc1
  buffer_load_dwordx4 v[48:51], v57, s[16:19], 0 offen sc1
  s_waitcnt vmcnt(0)
  v_xor_b32 v33, v33, v60
  v_xor_b32 v35, v35, v60
  v_or_b32 v8, v33, v35
  v_xor_b32 v37, v37, v60
  v_xor_b32 v39, v39, v60
  v_or3_b32 v8, v8, v37, v39
  v_xor_b32 v41, v41, v60
  v_xor_b32 v43, v43, v60
  v_or3_b32 v8, v8, v41, v43
  v_xor_b32 v45, v45, v60
  v_xor_b32 v47, v47, v60
  v_or3_b32 v8, v8, v45, v47
  v_xor_b32 v9, v50, v6
  v_xor_b32 v10, v51, v6
  v_or_b32 v9, v9, v10
  v_and_or_b32 v8, v8, s50, v9
  v_cmp_ne_u32 vcc, 0, v8
  s_cbranch_vccz L_goto
  s_sub_u32 s51, s51, 16
  s_cbranch_scc0 L_pollo
L_goto:
  v_mov_b32 v9, v48
  s_nop 1
  v_max_f32_dpp v9, v9, v9 quad_perm:[1,0,3,2] row_mask:0xf bank_mask:0xf
  s_nop 1
  v_max_f32_dpp v9, v9, v9 quad_perm:[2,3,0,1] row_mask:0xf bank_mask:0xf
  v_mov_b32 v10, v9
  s_nop 1
  v_permlane16_swap_b32 v9, v10
  v_max_f32 v9, v9, v10
  v_mov_b32 v10, v9
  s_nop 1
  v_permlane32_swap_b32 v9, v10
  v_max_f32 v9, v9, v10
  v_sub_f32 v9, v48, v9
  v_mul_f32 v9, s48, v9
  v_exp_f32 v9, v9
  s_nop 0
  v_mul_f32 v8, v9, v49
  s_nop 1
  v_add_f32_dpp v8, v8, v8 quad_perm:[1,0,3,2] row_mask:0xf bank_mask:0xf
  s_nop 1
  v_add_f32_dpp v8, v8, v8 quad_perm:[2,3,0,1] row_mask:0xf bank_mask:0xf
  v_mov_b32 v10, v8
  s_nop 1
  v_permlane16_swap_b32 v8, v10
  v_add_f32 v8, v8, v10
  v_mov_b32 v10, v8
  s_nop 1
  v_permlane32_swap_b32 v8, v10
  v_add_f32 v8, v8, v10
  v_rcp_f32 v8, v8
  s_nop 0
  v_mul_f32 v9, v9, v8
  s_nop 1
  v_mul_f32_dpp v20, v9, v32 row_newbcast:0 row_mask:0xf bank_mask:0xf
  v_mul_f32_dpp v21, v9, v33 row_newbcast:0 row_mask:0xf bank_mask:0xf
  v_mul_f32_dpp v22, v9, v34 row_newbcast:0 row_mask:0xf bank_mask:0xf
  v_mul_f32_dpp v23, v9, v35 row_newbcast:0 row_mask:0xf bank_mask:0xf
  v_fmac_f32_dpp v20, v9, v36 row_newbcast:1 row_mask:0xf bank_mask:0xf
  v_fmac_f32_dpp v21, v9, v37 row_newbcast:1 row_mask:0xf bank_mask:0xf
  v_fmac_f32_dpp v22, v9, v38 row_newbcast:1 row_mask:0xf bank_mask:0xf
  v_fmac_f32_dpp v23, v9, v39 row_newbcast:1 row_mask:0xf bank_mask:0xf
  v_fmac_f32_dpp v20, v9, v40 row_newbcast:2 row_mask:0xf bank_mask:0xf
  v_fmac_f32_dpp v21, v9, v41 row_newbcast:2 row_mask:0xf bank_mask:0xf
  v_fmac_f32_dpp v22, v9, v42 row_newbcast:2 row_mask:0xf bank_mask:0xf
  v_fmac_f32_dpp v23, v9, v43 row_newbcast:2 row_mask:0xf bank_mask:0xf
  v_fmac_f32_dpp v20, v9, v44 row_newbcast:3 row_mask:0xf bank_mask:0xf
  v_fmac_f32_dpp v21, v9, v45 row_newbcast:3 row_mask:0xf bank_mask:0xf
  v_fmac_f32_dpp v22, v9, v46 row_newbcast:3 row_mask:0xf bank_mask:0xf
  v_fmac_f32_dpp v23, v9, v47 row_newbcast:3 row_mask:0xf bank_mask:0xf
  v_permlane16_swap_b32 v20, v21
  s_nop 0
  v_permlane16_swap_b32 v22, v23
  v_add_f32 v20, v20, v21
  v_add_f32 v22, v22, v23
  s_nop 1
  v_permlane32_swap_b32 v20, v22
  v_add_f32 v20, v20, v22
  v_cvt_pk_bf16_f32 v7, v20, v20
  s_nop 1
  v_and_b32_dpp v20, v7, v52 row_newbcast:0 row_mask:0xf bank_mask:0xf
  v_and_b32_dpp v21, v7, v53 row_newbcast:0 row_mask:0xf bank_mask:0xf
  v_and_b32_dpp v22, v7, v54 row_newbcast:0 row_mask:0xf bank_mask:0xf
  v_and_b32_dpp v23, v7, v55 row_newbcast:0 row_mask:0xf bank_mask:0xf
  v_and_b32_dpp v24, v7, v52 row_newbcast:1 row_mask:0xf bank_mask:0xf
  v_and_b32_dpp v25, v7, v53 row_newbcast:1 row_mask:0xf bank_mask:0xf
  v_and_b32_dpp v26, v7, v54 row_newbcast:1 row_mask:0xf bank_mask:0xf
  v_and_b32_dpp v27, v7, v55 row_newbcast:1 row_mask:0xf bank_mask:0xf
  v_mfma_f32_16x16x32_bf16 v[16:19], v[128:131], v[20:23], v[16:19]
  v_and_b32_dpp v20, v7, v52 row_newbcast:2 row_mask:0xf bank_mask:0xf
  v_and_b32_dpp v21, v7, v53 row_newbcast:2 row_mask:0xf bank_mask:0xf
  v_and_b32_dpp v22, v7, v54 row_newbcast:2 row_mask:0xf bank_mask:0xf
  v_and_b32_dpp v23, v7, v55 row_newbcast:2 row_mask:0xf bank_mask:0xf
  v_mfma_f32_16x16x32_bf16 v[16:19], v[132:135], v[24:27], v[16:19]
  v_and_b32_dpp v24, v7, v52 row_newbcast:3 row_mask:0xf bank_mask:0xf
  v_and_b32_dpp v25, v7, v53 row_newbcast:3 row_mask:0xf bank_mask:0xf
  v_and_b32_dpp v26, v7, v54 row_newbcast:3 row_mask:0xf bank_mask:0xf
  v_and_b32_dpp v27, v7, v55 row_newbcast:3 row_mask:0xf bank_mask:0xf
  v_mfma_f32_16x16x32_bf16 v[16:19], v[136:139], v[20:23], v[16:19]
  v_and_b32_dpp v20, v7, v52 row_newbcast:4 row_mask:0xf bank_mask:0xf
  v_and_b32_dpp v21, v7, v53 row_newbcast:4 row_mask:0xf bank_mask:0xf
  v_and_b32_dpp v22, v7, v54 row_newbcast:4 row_mask:0xf bank_mask:0xf
  v_and_b32_dpp v23, v7, v55 row_newbcast:4 row_mask:0xf bank_mask:0xf
  v_mfma_f32_16x16x32_bf16 v[16:19], v[140:143], v[24:27], v[16:19]
  v_and_b32_dpp v24, v7, v52 row_newbcast:5 row_mask:0xf bank_mask:0xf
  v_and_b32_dpp v25, v7, v53 row_newbcast:5 row_mask:0xf bank_mask:0xf
  v_and_b32_dpp v26, v7, v54 row_newbcast:5 row_mask:0xf bank_mask:0xf
  v_and_b32_dpp v27, v7, v55 row_newbcast:5 row_mask:0xf bank_mask:0xf
  v_mfma_f32_16x16x32_bf16 v[16:19], v[144:147], v[20:23], v[16:19]
  v_and_b32_dpp v20, v7, v52 row_newbcast:6 row_mask:0xf bank_mask:0xf
  v_and_b32_dpp v21, v7, v53 row_newbcast:6 row_mask:0xf bank_mask:0xf
  v_and_b32_dpp v22, v7, v54 row_newbcast:6 row_mask:0xf bank_mask:0xf
  v_and_b32_dpp v23, v7, v55 row_newbcast:6 row_mask:0xf bank_mask:0xf
  v_mfma_f32_16x16x32_bf16 v[16:19], v[148:151], v[24:27], v[16:19]
  v_and_b32_dpp v24, v7, v52 row_newbcast:7 row_mask:0xf bank_mask:0xf
  v_and_b32_dpp v25, v7, v53 row_newbcast:7 row_mask:0xf bank_mask:0xf
  v_and_b32_dpp v26, v7, v54 row_newbcast:7 row_mask:0xf bank_mask:0xf
  v_and_b32_dpp v27, v7, v55 row_newbcast:7 row_mask:0xf bank_mask:0xf
  v_mfma_f32_16x16x32_bf16 v[16:19], v[152:155], v[20:23], v[16:19]
  v_and_b32_dpp v20, v7, v52 row_newbcast:8 row_mask:0xf bank_mask:0xf
  v_and_b32_dpp v21, v7, v53 row_newbcast:8 row_mask:0xf bank_mask:0xf
  v_and_b32_dpp v22, v7, v54 row_newbcast:8 row_mask:0xf bank_mask:0xf
  v_and_b32_dpp v23, v7, v55 row_newbcast:8 row_mask:0xf bank_mask:0xf
  v_mfma_f32_16x16x32_bf16 v[16:19], v[156:159], v[24:27], v[16:19]
  v_and_b32_dpp v24, v7, v52 row_newbcast:9 row_mask:0xf bank_mask:0xf
  v_and_b32_dpp v25, v7, v53 row_newbcast:9 row_mask:0xf bank_mask:0xf
  v_and_b32_dpp v26, v7, v54 row_newbcast:9 row_mask:0xf bank_mask:0xf
  v_and_b32_dpp v27, v7, v55 row_newbcast:9 row_mask:0xf bank_mask:0xf
  v_mfma_f32_16x16x32_bf16 v[16:19], v[160:163], v[20:23], v[16:19]
  v_and_b32_dpp v20, v7, v52 row_newbcast:10 row_mask:0xf bank_mask:0xf
  v_and_b32_dpp v21, v7, v53 row_newbcast:10 row_mask:0xf bank_mask:0xf
  v_and_b32_dpp v22, v7, v54 row_newbcast:10 row_mask:0xf bank_mask:0xf
  v_and_b32_dpp v23, v7, v55 row_newbcast:10 row_mask:0xf bank_mask:0xf
  v_mfma_f32_16x16x32_bf16 v[16:19], v[164:167], v[24:27], v[16:19]
  v_and_b32_dpp v24, v7, v52 row_newbcast:11 row_mask:0xf bank_mask:0xf
  v_and_b32_dpp v25, v7, v53 row_newbcast:11 row_mask:0xf bank_mask:0xf
  v_and_b32_dpp v26, v7, v54 row_newbcast:11 row_mask:0xf bank_mask:0xf
  v_and_b32_dpp v27, v7, v55 row_newbcast:11 row_mask:0xf bank_mask:0xf
  v_mfma_f32_16x16x32_bf16 v[16:19], v[168:171], v[20:23], v[16:19]
  v_and_b32_dpp v20, v7, v52 row_newbcast:12 row_mask:0xf bank_mask:0xf
  v_and_b32_dpp v21, v7, v53 row_newbcast:12 row_mask:0xf bank_mask:0xf
  v_and_b32_dpp v22, v7, v54 row_newbcast:12 row_mask:0xf bank_mask:0xf
  v_and_b32_dpp v23, v7, v55 row_newbcast:12 row_mask:0xf bank_mask:0xf
  v_mfma_f32_16x16x32_bf16 v[16:19], v[172:175], v[24:27], v[16:19]
  v_and_b32_dpp v24, v7, v52 row_newbcast:13 row_mask:0xf bank_mask:0xf
  v_and_b32_dpp v25, v7, v53 row_newbcast:13 row_mask:0xf bank_mask:0xf
  v_and_b32_dpp v26, v7, v54 row_newbcast:13 row_mask:0xf bank_mask:0xf
  v_and_b32_dpp v27, v7, v55 row_newbcast:13 row_mask:0xf bank_mask:0xf
  v_mfma_f32_16x16x32_bf16 v[16:19], v[176:179], v[20:23], v[16:19]
  v_and_b32_dpp v20, v7, v52 row_newbcast:14 row_mask:0xf bank_mask:0xf
  v_and_b32_dpp v21, v7, v53 row_newbcast:14 row_mask:0xf bank_mask:0xf
  v_and_b32_dpp v22, v7, v54 row_newbcast:14 row_mask:0xf bank_mask:0xf
  v_and_b32_dpp v23, v7, v55 row_newbcast:14 row_mask:0xf bank_mask:0xf
  v_mfma_f32_16x16x32_bf16 v[16:19], v[180:183], v[24:27], v[16:19]
  v_and_b32_dpp v24, v7, v52 row_newbcast:15 row_mask:0xf bank_mask:0xf
  v_and_b32_dpp v25, v7, v53 row_newbcast:15 row_mask:0xf bank_mask:0xf
  v_and_b32_dpp v26, v7, v54 row_newbcast:15 row_mask:0xf bank_mask:0xf
  v_and_b32_dpp v27, v7, v55 row_newbcast:15 row_mask:0xf bank_mask:0xf
  v_mfma_f32_16x16x32_bf16 v[16:19], v[184:187], v[20:23], v[16:19]
  s_nop 0
  v_mfma_f32_16x16x32_bf16 v[16:19], v[188:191], v[24:27], v[16:19]
  s_nop 7
  ds_write_b128 v59, v[16:19]
  s_waitcnt lgkmcnt(0)
  s_barrier
  s_cmp_lg_u32 s40, 0
  s_cbranch_scc1 L_hdone
  ds_read_b128 v[36:39], v59 offset:1024
  ds_read_b128 v[40:43], v59 offset:2048
  ds_read_b128 v[44:47], v59 offset:3072
  s_waitcnt lgkmcnt(0)
  v_add_f32 v16, v16, v36
  v_add_f32 v40, v40, v44
  v_add_f32 v17, v17, v37
  v_add_f32 v41, v41, v45
  v_add_f32 v18, v18, v38
  v_add_f32 v42, v42, v46
  v_add_f32 v19, v19, v39
  v_add_f32 v43, v43, v47
  v_add_f32 v16, v16, v40
  v_add_f32 v17, v17, v41
  v_add_f32 v18, v18, v42
  v_add_f32 v19, v19, v43
  v_perm_b32 v17, v17, v6, s49
  v_perm_b32 v19, v19, v6, s49
  buffer_store_dwordx4 v[16:19], v58, s[16:19], 0 offen sc1
  s_cmp_lg_u32 s39, 0
  s_cbranch_scc1 L_hdone
  s_lshl_b32 s42, s41, 13
  s_add_u32 s42, s42, 0x220000
  v_lshl_add_u32 v4, v1, 4, s42
  s_mul_i32 s42, s38, 896
  s_mul_i32 s43, s37, 256
  s_add_u32 s42, s42, s43
  v_bfe_u32 v9, v1, 3, 2
  v_lshlrev_b32 v5, 6, v9
  v_lshrrev_b32 v10, 5, v1
  v_lshl_add_u32 v5, v10, 4, v5
  v_and_b32 v10, 7, v1
  v_lshl_add_u32 v5, v10, 1, v5
  v_add_u32 v9, s43, v5
  v_add_u32 v5, s42, v5
  v_add_u32 v56, 32, v5
  v_mov_b32 v10, 0x80000000
  v_cmp_gt_u32 vcc, 0x380, v9
  s_nop 1
  v_cndmask_b32 v5, v10, v5, vcc
  v_cndmask_b32 v56, v10, v56, vcc
L_polly:
  buffer_load_dwordx4 v[64:67], v4, s[16:19], 0 offen offset:0 sc1
  buffer_load_dwordx4 v[68:71], v4, s[16:19], 0 offen offset:1024 sc1
  buffer_load_dwordx4 v[72:75], v4, s[16:19], 0 offen offset:2048 sc1
  buffer_load_dwordx4 v[76:79], v4, s[16:19], 0 offen offset:3072 sc1
  buffer_load_dwordx4 v[80:83], v4, s[16:19], s62 offen offset:0 sc1
  buffer_load_dwordx4 v[84:87], v4, s[16:19], s62 offen offset:1024 sc1
  buffer_load_dwordx4 v[88:91], v4, s[16:19], s62 offen offset:2048 sc1
  buffer_load_dwordx4 v[92:95], v4, s[16:19], s62 offen offset:3072 sc1
  s_waitcnt vmcnt(0)
  v_xor_b32 v65, v65, v60
  v_xor_b32 v67, v67, v60
  v_or_b32 v8, v65, v67
  v_xor_b32 v69, v69, v60
  v_xor_b32 v71, v71, v60
  v_or3_b32 v8, v8, v69, v71
  v_xor_b32 v73, v73, v60
  v_xor_b32 v75, v75, v60
  v_or3_b32 v8, v8, v73, v75
  v_xor_b32 v77, v77, v60
  v_xor_b32 v79, v79, v60
  v_or3_b32 v8, v8, v77, v79
  v_xor_b32 v81, v81, v60
  v_xor_b32 v83, v83, v60
  v_or3_b32 v8, v8, v81, v83
  v_xor_b32 v85, v85, v60
  v_xor_b32 v87, v87, v60
  v_or3_b32 v8, v8, v85, v87
  v_xor_b32 v89, v89, v60
  v_xor_b32 v91, v91, v60
  v_or3_b32 v8, v8, v89, v91
  v_xor_b32 v93, v93, v60
  v_xor_b32 v95, v95, v60
  v_or3_b32 v8, v8, v93, v95
  v_and_b32 v8, s50, v8
  v_cmp_ne_u32 vcc, 0, v8
  s_cbranch_vccz L_goty
  s_sub_u32 s51, s51, 16
  s_cbranch_scc0 L_polly
L_goty:
  v_add_f32 v64, v64, v80
  v_add_f32 v65, v65, v81
  v_add_f32 v66, v66, v82
  v_add_f32 v67, v67, v83
  v_add_f32 v68, v68, v84
  v_add_f32 v69, v69, v85
  v_add_f32 v70, v70, v86
  v_add_f32 v71, v71, v87
  v_add_f32 v72, v72, v88
  v_add_f32 v73, v73, v89
  v_add_f32 v74, v74, v90
  v_add_f32 v75, v75, v91
  v_add_f32 v76, v76, v92
  v_add_f32 v77, v77, v93
  v_add_f32 v78, v78, v94
  v_add_f32 v79, v79, v95
  v_add_f32 v64, v64, v72
  v_add_f32 v65, v65, v73
  v_add_f32 v66, v66, v74
  v_add_f32 v67, v67, v75
  v_add_f32 v68, v68, v76
  v_add_f32 v69, v69, v77
  v_add_f32 v70, v70, v78
  v_add_f32 v71, v71, v79
  v_add_f32 v64, v64, v68
  v_add_f32 v65, v65, v69
  v_add_f32 v66, v66, v70
  v_add_f32 v67, v67, v71
  v_permlane32_swap_b32 v64, v65
  s_nop 0
  v_permlane32_swap_b32 v66, v67
  v_add_f32 v64, v64, v65
  v_add_f32 v66, v66, v67
  v_cvt_pk_bf16_f32 v64, v64, v64
  v_cvt_pk_bf16_f32 v66, v66, v66
  buffer_store_short v64, v5, s[32:35], 0 offen
  buffer_store_short v66, v56, s[32:35], 0 offen
  s_or_b32 s42, s36, s37
  s_cmp_lg_u32 s42, 0
  s_cbranch_scc1 L_hdone
  s_mov_b64 exec, 1
  buffer_store_dword v6, off, s[16:19], 0 sc1
  s_mov_b64 exec, -1
L_hdone:
L_end:
  s_endpgm
.section .rodata,"a"
.p2align 6
.amdhsa_kernel standalone__mha_block_cached__decode_kernel
  .amdhsa_next_free_vgpr 256
  .amdhsa_next_free_sgpr 102
  .amdhsa_accum_offset 256
  .amdhsa_group_segment_fixed_size 0
  .amdhsa_kernarg_size 64
  .amdhsa_user_sgpr_count 2
  .amdhsa_user_sgpr_kernarg_segment_ptr 1
  .amdhsa_system_sgpr_workgroup_id_x 1
.end_amdhsa_kernel
```
